```python
import torch

def _softmax(x, axis=-1):
    return torch.softmax(x, dim=axis)
def _gelu(x):
    return torch.nn.functional.gelu(x, approximate="tanh")
def _silu(x):
    return torch.nn.functional.silu(x)
def _sigmoid(x):
    return torch.sigmoid(x)
def _layernorm(x, axis=-1, eps=1e-5):
    m = x.mean(dim=axis, keepdim=True)
    v = x.var(dim=axis, keepdim=True, unbiased=False)
    return (x - m) / torch.sqrt(v + eps)
def _scatter_add(tgt, idx, src, axis=0):
    return tgt.clone().index_add_(axis, idx, src)
def _segment_sum(src, seg, n):
    out = torch.zeros((n,) + src.shape[1:], dtype=src.dtype)
    return out.index_add_(0, seg, src)
def _pad(x, pw):
    flat = tuple(v for pair in reversed(pw) for v in pair)
    return torch.nn.functional.pad(x, flat)

kernel_name = 'concat_heads__softmax_full_mha__ssm_conv_s5__prompt'

def setup_inputs():

    _w = (lambda a: (lambda t: t.to(torch.bfloat16) if t.is_floating_point() else t)(torch.as_tensor(a)))
    def _A_setup():
        B, S, D = 1, 2048, 576
        return {
            "x": _w((lambda *s: torch.randn(*s, dtype=torch.bfloat16) * 0.2)(B, S, D)),
            "wqkv": _w((lambda *s: torch.randn(*s, dtype=torch.bfloat16) * 0.2)(D, 3 * D)),
            "wo": _w((lambda *s: torch.randn(*s, dtype=torch.bfloat16) * 0.05)(D, D)),
        }
    _A_in = _A_setup()

    def _B_setup():
        B, S, D = 1, 2048, 576
        P = D
        Lambda_re = -0.5 * (lambda _x: torch.exp(torch.as_tensor(_x)))((lambda *s: torch.randn(*s, dtype=torch.bfloat16) * 0.8)(P))
        Lambda_im = (lambda *s: torch.randn(*s, dtype=torch.bfloat16) * 0.8)(P) * 1.0
        B_re = (lambda *s: torch.randn(*s, dtype=torch.bfloat16) * 0.8)(P, D) * (D ** -0.5)
        B_im = (lambda *s: torch.randn(*s, dtype=torch.bfloat16) * 0.8)(P, D) * (D ** -0.5)
        C_re = (lambda *s: torch.randn(*s, dtype=torch.bfloat16) * 0.8)(D, P) * (P ** -0.5)
        C_im = (lambda *s: torch.randn(*s, dtype=torch.bfloat16) * 0.8)(D, P) * (P ** -0.5)
        log_dt = (lambda *s: torch.randn(*s, dtype=torch.bfloat16) * 0.8)(P) * 0.3 - 2.0
        Dskip = (lambda *s: torch.randn(*s, dtype=torch.bfloat16) * 0.8)(D)
        return {
            "x": _w((lambda *s: torch.randn(*s, dtype=torch.bfloat16) * 0.05)(B, S, D)),
            "Lambda_re": _w(Lambda_re),
            "Lambda_im": _w(Lambda_im),
            "B_re": _w(B_re),
            "B_im": _w(B_im),
            "C_re": _w(C_re),
            "C_im": _w(C_im),
            "log_dt": _w(log_dt),
            "Dskip": _w(Dskip),
        }
    _B_in = _B_setup()

    return {
        "A_x": _A_in["x"],
        "A_wqkv": _A_in["wqkv"],
        "A_wo": _A_in["wo"],
        "B_x": _B_in["x"],
        "B_Lambda_re": _B_in["Lambda_re"],
        "B_Lambda_im": _B_in["Lambda_im"],
        "B_B_re": _B_in["B_re"],
        "B_B_im": _B_in["B_im"],
        "B_C_re": _B_in["C_re"],
        "B_C_im": _B_in["C_im"],
        "B_log_dt": _B_in["log_dt"],
        "B_Dskip": _B_in["Dskip"],
    }

def reference(A_x, A_wqkv, A_wo, B_x, B_Lambda_re, B_Lambda_im, B_B_re, B_B_im, B_C_re, B_C_im, B_log_dt, B_Dskip):
    def _A_ref(x, wqkv, wo):
        B, S, D = x.shape
        H = 32; Dh = D // H
        qkv = (lambda x, *d: x.permute(*d))((x @ wqkv).reshape(B, S, 3, H, Dh), 2, 0, 3, 1, 4)
        q, k, v = qkv[0], qkv[1], qkv[2]
        scale = Dh ** -0.5
        scores = torch.einsum("bhqd,bhkd->bhqk", q, k) * scale
        p = _softmax(scores, axis=-1)
        o = torch.einsum("bhqk,bhkd->bhqd", p, v)
        return (lambda x, *d: x.permute(*d))(o, 0, 2, 1, 3).reshape(B, S, D) @ wo

    def _B_ref(x, Lambda_re, Lambda_im, B_re, B_im, C_re, C_im, log_dt, Dskip):
        Bsz, L, H = x.shape
        Lam = Lambda_re + 1j * Lambda_im
        Bmat = B_re + 1j * B_im
        Cmat = C_re + 1j * C_im
        dt = torch.exp(log_dt)
        Lam_bar = torch.exp(dt * Lam)
        B_bar = ((Lam_bar - 1.0) / Lam)[:, None] * Bmat
        Bu = torch.einsum("bld,pd->blp", x + 0j, B_bar)
        h = torch.zeros_like(Bu[:, 0, :])
        hs = []
        for t in range(L):
            h = Lam_bar[None, :] * h + Bu[:, t, :]
            hs.append(h)
        hseq = torch.stack(hs, 1)
        y = 2.0 * torch.einsum("blp,dp->bld", hseq, Cmat).real + x * Dskip[None, None, :]
        return y

    a = _A_ref(A_x, A_wqkv, A_wo)
    b = _B_ref(B_x, B_Lambda_re, B_Lambda_im, B_B_re, B_B_im, B_C_re, B_C_im, B_log_dt, B_Dskip)
    return torch.concatenate([a, b], axis=-1)
```

```asm
; @launch kernel=concat_heads__softmax_full_mha__ssm_conv_s5__prompt_kernel grid=(256,1,1) block=(768,1,1) lds=163840
.amdgcn_target "amdgcn-amd-amdhsa--gfx950"
.text
.globl concat_heads__softmax_full_mha__ssm_conv_s5__prompt_kernel
.p2align 8
.type concat_heads__softmax_full_mha__ssm_conv_s5__prompt_kernel,@function
concat_heads__softmax_full_mha__ssm_conv_s5__prompt_kernel:
L_code0:
  s_cmp_ge_u32 s2, 256
  s_cbranch_scc1 L_end
  s_load_dwordx16 s[64:79], s[0:1], 0
  s_load_dwordx8 s[80:87], s[0:1], 64
  s_load_dwordx4 s[88:91], s[0:1], 96
  s_load_dwordx2 s[92:93], s[0:1], 112
  v_lshrrev_b32 v1, 6, v0
  v_and_b32 v2, 63, v0
  v_readfirstlane_b32 s3, v1
  v_lshlrev_b32 v3, 4, v2
  v_and_b32 v1, 31, v0
  s_and_b32 s20, s2, 7
  s_lshr_b32 s21, s2, 3
  s_and_b32 s30, s20, 3
  s_lshl_b32 s30, s30, 2
  s_and_b32 s31, s21, 3
  s_add_u32 s22, s30, s31
  s_lshl_b32 s39, s20, 2
  s_add_u32 s39, s39, s31
  s_lshr_b32 s30, s20, 2
  s_lshr_b32 s31, s21, 2
  s_mul_i32 s32, s30, 7
  s_add_u32 s23, s32, s31
  s_mul_i32 s32, s30, 9
  s_add_u32 s25, s32, s31
  s_add_u32 s26, s32, 8
  s_cmp_ge_u32 s23, 9
  s_cselect_b32 s24, 1, 0
  s_cmp_ge_u32 s21, 28
  s_cselect_b32 s24, 2, s24
  s_and_b32 s51, s3, 3
  s_and_b32 s30, s21, 3
  s_lshr_b32 s31, s21, 2
  s_add_u32 s30, s30, s31
  s_mul_i32 s31, s30, 43
  s_lshr_b32 s31, s31, 7
  s_mul_i32 s31, s31, 3
  s_sub_u32 s30, s30, s31
  s_mul_i32 s28, s30, 3
  s_cmp_lt_u32 s3, 4
  s_cbranch_scc1 L_aux
  s_cmp_eq_u32 s24, 2
  s_cbranch_scc1 L_p1l_sp
  s_mov_b32 s41, 0
  s_sub_u32 s42, 9, s28
  s_lshl_b32 s45, s51, 12
  s_cmp_ge_u32 s3, 8
  s_cbranch_scc1 L_p1l_w
  s_cmp_eq_u32 s24, 0
  s_cselect_b32 s46, 2, 1
  s_cselect_b32 s47, 32, 16
  s_cselect_b32 s48, 16, 4
  s_lshr_b32 s30, s51, 1
  s_lshl_b32 s30, s30, 6
  s_and_b32 s31, s51, 1
  s_add_u32 s30, s30, s31
  s_lshl_b32 s31, s51, 5
  s_cmp_eq_u32 s24, 0
  s_cselect_b32 s30, s30, s31
  s_lshl_b32 s31, s22, 7
  s_add_u32 s30, s30, s31
  s_mul_i32 s43, s30, 1152
  s_mov_b32 s44, 128
  v_lshrrev_b32 v12, 3, v2
  v_and_b32 v13, 7, v2
  v_lshrrev_b32 v14, 1, v12
  v_xor_b32 v13, v13, v14
  v_lshrrev_b32 v14, 2, v12
  v_and_b32 v12, 3, v12
  v_mul_u32_u24 v14, 8, v14
  v_mul_u32_u24 v12, s46, v12
  v_add_u32 v12, v12, v14
  v_mul_u32_u24 v12, 1152, v12
  v_lshl_add_u32 v4, v13, 4, v12
  v_xor_b32 v13, 4, v13
  v_lshl_add_u32 v5, v13, 4, v12
  s_mul_i32 s34, s48, 1152
  s_sub_u32 s34, s34, 1024
  v_add_u32 v5, s34, v5
  s_mul_i32 s34, s47, 1152
  s_sub_u32 s34, s34, 2048
  v_add_u32 v6, s34, v4
  v_add_u32 v7, s34, v5
  s_waitcnt lgkmcnt(0)
  s_mov_b32 s8, s64
  s_and_b32 s9, s65, 0xffff
  s_mov_b32 s10, 2359296
  s_mov_b32 s11, 0x20000
  s_branch L_p1l_go
L_p1l_w:
  s_mul_i32 s30, s51, 55296
  s_lshl_b32 s31, s23, 8
  s_add_u32 s43, s30, s31
  s_mov_b32 s44, 221184
  s_add_u32 s45, s45, 16384
  v_lshrrev_b32 v12, 4, v2
  v_and_b32 v13, 15, v2
  v_lshlrev_b32 v14, 2, v12
  v_xor_b32 v13, v13, v14
  v_mul_u32_u24 v12, 3456, v12
  v_lshl_add_u32 v4, v13, 4, v12
  v_add_u32 v5, 12800, v4
  v_add_u32 v6, 25600, v4
  v_add_u32 v7, 38400, v4
  s_waitcnt lgkmcnt(0)
  s_mov_b32 s8, s66
  s_and_b32 s9, s67, 0xffff
  s_mov_b32 s10, 1990656
  s_mov_b32 s11, 0x20000
L_p1l_go:
  s_mul_i32 s30, s28, s44
  s_add_u32 s43, s43, s30
  s_mul_i32 s46, s44, 9
L_p1l_issue:
  s_mov_b32 m0, s45
  s_add_u32 s41, s41, 1
  buffer_load_dwordx4 v4, s[8:11], s43 offen offset:0 lds
  buffer_load_dwordx4 v5, s[8:11], s43 offen offset:1024 lds
  buffer_load_dwordx4 v6, s[8:11], s43 offen offset:2048 lds
  buffer_load_dwordx4 v7, s[8:11], s43 offen offset:3072 lds
  s_add_u32 s43, s43, s44
  s_cmp_eq_u32 s41, s42
  s_cselect_b32 s30, s46, 0
  s_sub_u32 s43, s43, s30
  s_add_u32 s45, s45, 32768
  s_sub_u32 s30, s45, 163840
  s_cmp_ge_u32 s45, 163840
  s_cselect_b32 s45, s30, s45
  s_cmp_lt_u32 s41, 3
  s_cbranch_scc1 L_p1l_issue
  s_waitcnt vmcnt(8)
  s_barrier
  s_cmp_lt_u32 s41, 9
  s_cbranch_scc1 L_p1l_issue
L_p1l_sp:
  s_waitcnt lgkmcnt(0)
  v_lshrrev_b32 v68, 3, v2
  v_and_b32 v69, 7, v2
  v_lshrrev_b32 v70, 1, v68
  v_xor_b32 v69, v69, v70
  v_lshrrev_b32 v70, 2, v68
  v_and_b32 v68, 3, v68
  v_mul_u32_u24 v70, 16, v70
  v_mul_u32_u24 v68, 1, v68
  v_add_u32 v68, v68, v70
  v_mul_u32_u24 v68, 1152, v68
  v_lshl_add_u32 v60, v69, 4, v68
  v_xor_b32 v69, 4, v69
  v_lshl_add_u32 v61, v69, 4, v68
  s_mul_i32 s34, 4, 1152
  s_sub_u32 s34, s34, 1024
  v_add_u32 v61, s34, v61
  s_mul_i32 s34, 8, 1152
  s_sub_u32 s34, s34, 2048
  v_add_u32 v62, s34, v60
  v_add_u32 v63, s34, v61
  v_lshrrev_b32 v68, 3, v2
  v_and_b32 v69, 7, v2
  v_lshrrev_b32 v70, 1, v68
  v_xor_b32 v69, v69, v70
  v_lshrrev_b32 v70, 2, v68
  v_and_b32 v68, 3, v68
  v_mul_u32_u24 v70, 4, v70
  v_mul_u32_u24 v68, 1, v68
  v_add_u32 v68, v68, v70
  v_mul_u32_u24 v68, 1152, v68
  v_lshl_add_u32 v64, v69, 4, v68
  v_xor_b32 v69, 4, v69
  v_lshl_add_u32 v65, v69, 4, v68
  s_mul_i32 s34, 8, 1152
  s_sub_u32 s34, s34, 1024
  v_add_u32 v65, s34, v65
  s_mov_b32 s8, s70
  s_and_b32 s9, s71, 0xffff
  s_mov_b32 s10, 2359296
  s_mov_b32 s11, 0x20000
  s_cmp_lt_u32 s51, 2
  s_cselect_b32 s12, s76, s78
  s_cselect_b32 s13, s77, s79
  s_and_b32 s13, s13, 0xffff
  s_mov_b32 s14, 663552
  s_mov_b32 s15, 0x20000
  s_lshl_b32 s30, s22, 7
  s_lshl_b32 s31, s51, 5
  s_add_u32 s30, s30, s31
  s_mul_i32 s16, s30, 1152
  s_cmp_eq_u32 s24, 2
  s_cselect_b32 s30, s26, s25
  s_cselect_b32 s19, 18, 9
  s_lshl_b32 s30, s30, 5
  s_and_b32 s31, s51, 1
  s_lshl_b32 s31, s31, 4
  s_add_u32 s30, s30, s31
  s_mul_i32 s17, s30, 1152
  v_mov_b32 v66, 162304
  v_mov_b32 v67, 1
  s_lshr_b32 s27, s3, 3
  s_cmp_eq_u32 s24, 2
  s_cbranch_scc1 L_p1l_sp2
  s_lshl_b32 s30, s21, 2
  s_and_b32 s31, s51, 1
  s_add_u32 s30, s30, s31
  s_lshr_b32 s31, s3, 3
  s_lshl_b32 s31, s31, 1
  s_add_u32 s30, s30, s31
  s_mul_i32 s30, s30, 3072
  s_lshr_b32 s31, s20, 2
  s_mul_i32 s31, s31, 331776
  s_add_u32 s30, s30, s31
  buffer_load_dwordx4 v[80:83], v3, s[12:15], s30 offen offset:0
  buffer_load_dwordx4 v[80:83], v3, s[12:15], s30 offen offset:1024
  buffer_load_dwordx4 v[80:83], v3, s[12:15], s30 offen offset:2048
  s_waitcnt vmcnt(7)
  s_barrier
  s_xor_b32 s40, s27, 1
  s_waitcnt vmcnt(3)
  s_barrier
L_p1l_sp2:
  s_cmp_lg_u32 s3, 8
  s_cbranch_scc1 L_p1l_b
  v_lshlrev_b32 v9, 2, v2
  v_add_u32 v9, 159744, v9
  v_cmp_eq_u32 vcc, 8, v2
  v_mov_b32 v10, 4
  v_mov_b32 v8, 0
  v_cndmask_b32 v10, v8, v10, vcc
  ds_write_b32 v9, v10
  ds_write_b32 v9, v8 offset:2560
  ds_write_b32 v9, v8 offset:2816
  s_waitcnt lgkmcnt(0)
L_p1l_b:
  s_barrier
  s_mov_b32 s4, s92
  s_and_b32 s5, s93, 0xffff
  s_mov_b32 s6, 268435456
  s_mov_b32 s7, 0x20000
  s_cmp_lt_u32 s3, 8
  s_cbranch_scc1 L_attshare
  s_mov_b32 s43, 162304
  s_mov_b32 s45, 6
  s_cmp_eq_u32 s24, 2
  s_cselect_b32 s46, 4, 4
L_l1job:
  s_xor_b32 s40, s27, 1
  s_cmp_eq_u32 s27, 0
  s_cselect_b32 s42, 6, 9
  s_mov_b32 s41, 0
L_l1w:
  s_cmp_lt_u32 s40, 4
  s_cbranch_scc1 L_l1
  s_mov_b32 s33, 0
L_sp_1:
  ds_read_b32 v68, v69 offset:0
  s_add_u32 s33, s33, 1
  s_waitcnt lgkmcnt(0)
  v_readfirstlane_b32 s32, v68
  s_cmp_ge_u32 s32, 4
  s_cbranch_scc1 L_sp_1x
  s_cmp_lt_u32 s33, 320000
  s_cbranch_scc1 L_sp_1
L_sp_1x:
L_l1:
  s_add_u32 s31, s40, s28
  s_sub_u32 s30, s31, 9
  s_cmp_ge_u32 s31, 9
  s_cselect_b32 s31, s30, s31
  s_lshl_b32 s31, s31, 7
  s_and_b32 s18, s40, 3
  s_mul_i32 s18, s18, 24576
  s_add_u32 s18, s18, 0
  s_lshl_b32 s30, s51, 12
  s_add_u32 m0, s30, s18
  s_add_u32 s32, s31, s16
  buffer_load_dwordx4 v60, s[8:11], s32 offen offset:0 lds
  buffer_load_dwordx4 v61, s[8:11], s32 offen offset:1024 lds
  buffer_load_dwordx4 v62, s[8:11], s32 offen offset:2048 lds
  buffer_load_dwordx4 v63, s[8:11], s32 offen offset:3072 lds
  s_lshl_b32 s30, s51, 11
  s_add_u32 s30, s30, s18
  s_add_u32 m0, s30, 16384
  s_add_u32 s32, s31, s17
  buffer_load_dwordx4 v64, s[12:15], s32 offen offset:0 lds
  buffer_load_dwordx4 v65, s[12:15], s32 offen offset:1024 lds
L_l1e:
  s_cmp_lt_u32 s40, s45
  s_cselect_b32 s44, 2, 1
  s_add_u32 s44, s44, s40
  s_lshl_b32 s30, s44, 2
  s_add_u32 s30, s30, s43
  s_add_u32 s30, s30, 240
  v_mov_b32 v69, s30
  ds_read_b32 v68, v69
  s_cmp_eq_u32 s41, 0
  s_cbranch_scc1 L_l1n
  s_waitcnt vmcnt(6)
  s_mov_b64 exec, 1
  ds_add_u32 v66, v67 offset:0
  s_mov_b64 exec, -1
L_l1n:
  s_lshl_b32 s30, s40, 2
  s_add_u32 s30, s30, s43
  v_mov_b32 v66, s30
  s_mov_b32 s40, s44
  s_mov_b32 s41, 1
  s_waitcnt lgkmcnt(0)
  v_readfirstlane_b32 s32, v68
  s_cmp_lt_u32 s40, s46
  s_cselect_b32 s32, 4, s32
  s_cmp_ge_u32 s40, s42
  s_cselect_b32 s32, 0, s32
  s_cmp_ge_u32 s32, 4
  s_cbranch_scc1 L_l1
  s_waitcnt vmcnt(0)
  s_mov_b64 exec, 1
  ds_add_u32 v66, v67 offset:0
  s_mov_b64 exec, -1
  s_mov_b32 s41, 0
  s_cmp_lt_u32 s40, s42
  s_cbranch_scc1 L_l1w
  s_add_u32 s30, s43, 288
  v_mov_b32 v69, s30
  s_cmp_eq_u32 s19, 9
  s_cbranch_scc1 L_l1end
  s_mov_b32 s45, 0
  s_mov_b32 s19, 9
  s_sub_u32 s30, s26, s25
  s_mul_i32 s30, s30, 36864
  s_sub_u32 s17, s17, s30
  s_add_u32 s43, s43, 36
  s_mov_b32 s33, 0
L_sp_2:
  ds_read_b32 v68, v69 offset:0
  s_add_u32 s33, s33, 1
  s_waitcnt lgkmcnt(0)
  v_readfirstlane_b32 s32, v68
  s_cmp_ge_u32 s32, 4
  s_cbranch_scc1 L_sp_2x
  s_sleep 1
  s_cmp_lt_u32 s33, 320000
  s_cbranch_scc1 L_sp_2
L_sp_2x:
  s_branch L_l1job
L_l1end:
  s_mov_b32 s33, 0
L_sp_3:
  ds_read_b32 v68, v69 offset:0
  s_add_u32 s33, s33, 1
  s_waitcnt lgkmcnt(0)
  v_readfirstlane_b32 s32, v68
  s_cmp_ge_u32 s32, 4
  s_cbranch_scc1 L_sp_3x
  s_sleep 1
  s_cmp_lt_u32 s33, 320000
  s_cbranch_scc1 L_sp_3
L_sp_3x:
  v_mov_b32 v156, 159844
  v_mov_b32 v157, 1
  v_mov_b32 v155, 0
  v_mov_b32 v20, 159744
  v_mov_b32 v12, 0
  v_mov_b32 v13, 0
  v_mov_b32 v16, 0x3f803f80
  v_mov_b32 v17, 0x3f803f80
  v_mov_b32 v18, 0x3f803f80
  v_mov_b32 v19, 0x3f803f80
  v_mov_b32 v157, 1
  v_mov_b32 v20, 159744
  v_mov_b32 v16, 0x3f803f80
  v_mov_b32 v17, 0x3f803f80
  v_mov_b32 v18, 0x3f803f80
  v_mov_b32 v19, 0x3f803f80
  s_lshr_b32 s30, s39, 1
  s_mul_i32 s30, s30, 9
  s_and_b32 s31, s39, 1
  s_lshl_b32 s31, s31, 2
  s_add_u32 s36, s30, s31
  s_add_u32 s30, s36, s51
  s_lshl_b32 s30, s30, 10
  s_mul_i32 s31, 2, 591872
  s_add_u32 s30, s30, s31
  s_add_u32 s52, s30, 147456
  s_cmp_eq_u32 s51, 0
  s_cselect_b32 s54, 0, 290816
  s_add_u32 s54, s54, 4096
  s_mul_i32 s30, s39, 288
  s_mul_i32 s31, s51, 28032
  s_add_u32 s30, s30, s31
  s_mul_i32 s31, 2, 299008
  s_add_u32 s30, s30, s31
  s_add_u32 s55, s30, 5242880
  v_mul_u32_u24 v24, 27, v2
  v_lshrrev_b32 v24, 9, v24
  v_mul_u32_u24 v22, 19, v24
  v_sub_u32 v22, v2, v22
  v_cmp_gt_u32 vcc, 18, v22
  v_cmp_gt_u32 s[58:59], 3, v24
  v_cmp_gt_u32 s[60:61], 2, v24
  v_mul_u32_u24 v24, 9344, v24
  v_lshl_add_u32 v22, v22, 4, v24
  s_and_b64 s[58:59], s[58:59], vcc
  s_and_b64 s[60:61], s[60:61], vcc
  s_cmp_eq_u32 s51, 2
  s_cselect_b64 s[60:61], s[60:61], s[58:59]
  s_add_u32 s30, 2, 5
  s_and_b32 s30, s30, 7
  s_mul_i32 s56, s30, 19968
  v_mul_u32_u24 v23, 304, v1
  v_add_u32 v23, 10528, v23
  s_mov_b32 s33, 0
L_sp_5:
  ds_read_b32 v24, v20 offset:0
  s_add_u32 s33, s33, 1
  s_waitcnt lgkmcnt(0)
  v_readfirstlane_b32 s32, v24
  s_cmp_ge_u32 s32, 4
  s_cbranch_scc1 L_sp_5x
  s_sleep 2
  s_cmp_lt_u32 s33, 320000
  s_cbranch_scc1 L_sp_5
L_sp_5x:
  s_lshl_b32 s31, s51, 10
  s_add_u32 s31, s31, s56
  s_mov_b32 m0, s31
  s_add_u32 s30, s52, s54
  buffer_load_dwordx4 v3, s[4:7], s52 offen sc0 sc1 lds
  s_add_u32 m0, s31, 4096
  s_cmp_ge_u32 s51, 2
  buffer_load_dwordx4 v3, s[4:7], s30 offen sc0 sc1 lds
  s_cbranch_scc1 L_kd_6
  s_add_u32 m0, s31, 8192
  s_add_u32 s30, s52, 299008
  buffer_load_dwordx4 v3, s[4:7], s30 offen sc0 sc1 lds
L_kd_6:
  s_mul_i32 s31, s51, 912
  s_add_u32 s31, s31, s56
  s_add_u32 m0, s31, 10240
  s_mov_b64 exec, s[58:59]
  buffer_load_dwordx4 v22, s[4:7], s55 offen sc0 sc1 lds
  s_add_u32 m0, s31, 13888
  s_add_u32 s30, s55, 112128
  buffer_load_dwordx4 v22, s[4:7], s30 offen sc0 sc1 lds
  s_cmp_eq_u32 s51, 3
  s_cbranch_scc1 L_vd_7
  s_add_u32 m0, s31, 17536
  s_add_u32 s30, s55, 224256
  s_mov_b64 exec, s[60:61]
  buffer_load_dwordx4 v22, s[4:7], s30 offen sc0 sc1 lds
L_vd_7:
  s_mov_b64 exec, -1
  v_add_u32 v24, s56, v23
  ds_write_b128 v24, v[16:19]
  s_add_u32 s52, s52, 591872
  s_add_u32 s55, s55, 299008
  s_add_u32 s56, s56, 19968
  s_cmp_eq_u32 s56, 159744
  s_cselect_b32 s56, 0, s56
  s_mov_b32 s35, 0
  v_mov_b32 v21, 159752
L_hkv_4:
  s_lshl_b32 s31, s51, 10
  s_add_u32 s31, s31, s56
  s_mov_b32 m0, s31
  s_add_u32 s30, s52, s54
  buffer_load_dwordx4 v3, s[4:7], s52 offen sc0 sc1 lds
  s_add_u32 m0, s31, 4096
  s_cmp_ge_u32 s51, 2
  buffer_load_dwordx4 v3, s[4:7], s30 offen sc0 sc1 lds
  s_cbranch_scc1 L_kd_8
  s_add_u32 m0, s31, 8192
  s_add_u32 s30, s52, 299008
  buffer_load_dwordx4 v3, s[4:7], s30 offen sc0 sc1 lds
L_kd_8:
  s_mul_i32 s31, s51, 912
  s_add_u32 s31, s31, s56
  s_add_u32 m0, s31, 10240
  s_mov_b64 exec, s[58:59]
  buffer_load_dwordx4 v22, s[4:7], s55 offen sc0 sc1 lds
  s_add_u32 m0, s31, 13888
  s_add_u32 s30, s55, 112128
  buffer_load_dwordx4 v22, s[4:7], s30 offen sc0 sc1 lds
  s_cmp_eq_u32 s51, 3
  s_cbranch_scc1 L_vd_9
  s_add_u32 m0, s31, 17536
  s_add_u32 s30, s55, 224256
  s_mov_b64 exec, s[60:61]
  buffer_load_dwordx4 v22, s[4:7], s30 offen sc0 sc1 lds
L_vd_9:
  s_mov_b64 exec, -1
  v_add_u32 v24, s56, v23
  ds_write_b128 v24, v[16:19]
  s_add_u32 s52, s52, 591872
  s_add_u32 s55, s55, 299008
  s_add_u32 s56, s56, 19968
  s_cmp_eq_u32 s56, 159744
  s_cselect_b32 s56, 0, s56
  s_waitcnt vmcnt(4)
  s_mov_b64 exec, 1
  ds_add_u32 v21, v157 offset:0
  s_mov_b64 exec, -1
  v_add_u32 v21, 4, v21
  s_add_u32 s35, s35, 1
  s_cmp_lt_u32 s35, 5
  s_cbranch_scc1 L_hkv_4
  s_waitcnt vmcnt(0)
  s_mov_b64 exec, 1
  ds_add_u32 v21, v157 offset:0
  s_mov_b64 exec, -1
  s_lshl_b32 s37, s20, 1
  s_and_b32 s30, s21, 1
  s_add_u32 s37, s37, s30
  s_lshr_b32 s38, s21, 1
  s_lshl_b32 s57, s37, 2
  s_add_u32 s57, s57, s51
  s_mov_b32 s27, 0
  s_mov_b32 s33, 0
L_sp_10:
  ds_read_b32 v24, v20 offset:116
  s_add_u32 s33, s33, 1
  s_waitcnt lgkmcnt(0)
  v_readfirstlane_b32 s32, v24
  s_cmp_ge_u32 s32, 4
  s_cbranch_scc1 L_sp_10x
  s_sleep 16
  s_cmp_lt_u32 s33, 320000
  s_cbranch_scc1 L_sp_10
L_sp_10x:
L_hpf:
  s_cmp_ge_u32 s21, 30
  s_cbranch_scc1 L_hfin
  s_cmp_ge_u32 s21, 18
  s_cbranch_scc1 L_hpfa
  v_lshrrev_b32 v24, 3, v2
  v_and_b32 v25, 7, v2
  v_lshrrev_b32 v26, 1, v24
  v_xor_b32 v25, v25, v26
  v_lshrrev_b32 v26, 2, v24
  v_and_b32 v24, 3, v24
  v_mul_u32_u24 v26, 4, v26
  v_mul_u32_u24 v24, 1, v24
  v_add_u32 v24, v24, v26
  v_mul_u32_u24 v24, 1152, v24
  v_lshl_add_u32 v12, v25, 4, v24
  v_xor_b32 v25, 4, v25
  v_lshl_add_u32 v13, v25, 4, v24
  s_mul_i32 s34, 8, 1152
  s_sub_u32 s34, s34, 1024
  v_add_u32 v13, s34, v13
  s_mov_b32 s12, s80
  s_and_b32 s13, s81, 0xffff
  s_mov_b32 s14, 663552
  s_mov_b32 s15, 0x20000
  s_lshl_b32 s30, s38, 6
  s_lshl_b32 s31, s51, 4
  s_add_u32 s30, s30, s31
  s_mul_i32 s53, s30, 1152
  s_mov_b32 s40, 0
  v_and_b32 v24, 3, v2
  v_lshlrev_b32 v24, 2, v24
  v_add_u32 v24, 159808, v24
  s_mov_b32 s33, 0
  s_mov_b32 s30, 1342177280
L_pg_11:
  ds_read_b32 v25, v24
  s_add_u32 s33, s33, 1
  s_waitcnt lgkmcnt(0)
  v_cmp_gt_u32 vcc, 159756, v25
  s_cmp_gt_u32 s33, 160000
  s_cbranch_scc1 L_pg_11x
  s_cbranch_vccz L_pg_11x
  s_sleep 16
  s_branch L_pg_11
L_pg_11x:
  s_mov_b32 s40, 0
L_cl_12:
  s_lshl_b32 s30, s40, 13
  s_add_u32 s30, s30, 100352
  s_lshl_b32 s31, s51, 11
  s_add_u32 m0, s30, s31
  s_cmp_lt_u32 s40, 9
  s_cselect_b32 s12, s80, s82
  s_cselect_b32 s13, s81, s83
  s_cselect_b32 s31, 0, 9
  s_and_b32 s13, s13, 0xffff
  s_sub_u32 s31, s40, s31
  s_lshl_b32 s31, s31, 7
  s_add_u32 s32, s31, s53
  buffer_load_dwordx4 v12, s[12:15], s32 offen lds
  buffer_load_dwordx4 v13, s[12:15], s32 offen offset:1024 lds
  s_add_u32 s40, s40, 1
  s_cmp_lt_u32 s40, 7
  s_cbranch_scc1 L_cl_12
  s_cmp_lg_u32 s27, 0
  s_cbranch_scc1 L_hnp
  s_mov_b32 s16, s88
  s_and_b32 s17, s89, 0xffff
  s_mov_b32 s18, 9437184
  s_mov_b32 s19, 0x20000
  v_lshrrev_b32 v159, 5, v2
  v_bfe_u32 v160, v1, 1, 3
  v_xor_b32 v160, v160, v159
  v_lshlrev_b32 v161, 7, v1
  v_add_u32 v161, 0, v161
  v_xor_b32 v162, 0, v160
  v_lshl_add_u32 v4, v162, 4, v161
  v_xor_b32 v162, 2, v160
  v_lshl_add_u32 v5, v162, 4, v161
  v_xor_b32 v162, 4, v160
  v_lshl_add_u32 v6, v162, 4, v161
  v_xor_b32 v162, 6, v160
  v_lshl_add_u32 v7, v162, 4, v161
  v_add_u32 v8, 73728, v4
  v_add_u32 v9, 73728, v5
  v_add_u32 v10, 73728, v6
  v_add_u32 v11, 73728, v7
  s_mov_b32 s49, 1
  s_mul_i32 s34, s37, 384
  s_lshl_b32 s30, s51, 2
  s_add_u32 s34, s34, s30
  s_add_u32 s34, s34, 17828864
  v_min_u32 v158, 17, v2
  v_lshlrev_b32 v158, 4, v158
  s_mov_b32 s33, 0
L_pollF31:
  buffer_load_dword v159, v158, s[4:7], s34 offen sc0 sc1
  s_waitcnt vmcnt(0)
  v_cmp_ne_u32 vcc, 1, v159
  s_add_u32 s33, s33, 1
  s_cmp_gt_u32 s33, 20000
  s_cbranch_scc1 L_pollF31_x
  s_cbranch_vccz L_pollF31_x
  s_sleep 16
  s_branch L_pollF31
L_pollF31_x:
  s_mul_i32 s50, s57, 75776
  s_add_u32 s50, s50, 11571200
  s_lshl_b32 s31, s38, 11
  s_add_u32 s30, s50, s31
  s_add_u32 s30, s30, 18432
  buffer_load_dwordx4 v[48:51], v3, s[4:7], s50 offen offset:0 sc0 sc1
  buffer_load_dwordx4 v[52:55], v3, s[4:7], s50 offen offset:1024 sc0 sc1
  buffer_load_dwordx4 v[56:59], v3, s[4:7], s50 offen offset:2048 sc0 sc1
  buffer_load_dwordx4 v[60:63], v3, s[4:7], s50 offen offset:3072 sc0 sc1
  s_add_u32 s50, s50, 4096
  buffer_load_dwordx4 v[64:67], v3, s[4:7], s50 offen offset:0 sc0 sc1
  buffer_load_dwordx4 v[68:71], v3, s[4:7], s50 offen offset:1024 sc0 sc1
  buffer_load_dwordx4 v[72:75], v3, s[4:7], s50 offen offset:2048 sc0 sc1
  buffer_load_dwordx4 v[76:79], v3, s[4:7], s50 offen offset:3072 sc0 sc1
  s_add_u32 s50, s50, 4096
  buffer_load_dwordx4 v[80:83], v3, s[4:7], s50 offen offset:0 sc0 sc1
  buffer_load_dwordx4 v[84:87], v3, s[4:7], s50 offen offset:1024 sc0 sc1
  buffer_load_dwordx4 v[88:91], v3, s[4:7], s50 offen offset:2048 sc0 sc1
  buffer_load_dwordx4 v[92:95], v3, s[4:7], s50 offen offset:3072 sc0 sc1
  s_add_u32 s50, s50, 4096
  buffer_load_dwordx4 v[96:99], v3, s[4:7], s50 offen offset:0 sc0 sc1
  buffer_load_dwordx4 v[100:103], v3, s[4:7], s50 offen offset:1024 sc0 sc1
  buffer_load_dwordx4 v[104:107], v3, s[4:7], s50 offen offset:2048 sc0 sc1
  buffer_load_dwordx4 v[108:111], v3, s[4:7], s50 offen offset:3072 sc0 sc1
  s_add_u32 s50, s50, 4096
  buffer_load_dwordx4 v[112:115], v3, s[4:7], s50 offen offset:0 sc0 sc1
  buffer_load_dwordx4 v[116:119], v3, s[4:7], s50 offen offset:1024 sc0 sc1
L_hnp:
  v_and_b32 v24, 3, v2
  v_lshlrev_b32 v24, 2, v24
  v_add_u32 v24, 159808, v24
  s_mov_b32 s33, 0
  s_mov_b32 s30, 1342177280
L_pg_13:
  ds_read_b32 v25, v24
  s_add_u32 s33, s33, 1
  s_waitcnt lgkmcnt(0)
  v_cmp_gt_u32 vcc, 159768, v25
  s_cmp_gt_u32 s33, 160000
  s_cbranch_scc1 L_pg_13x
  s_cbranch_vccz L_pg_13x
  s_sleep 16
  s_branch L_pg_13
L_pg_13x:
  s_mov_b32 s40, 9
L_cl_14:
  s_lshl_b32 s30, s40, 13
  s_add_u32 s30, s30, 4294893568
  s_lshl_b32 s31, s51, 11
  s_add_u32 m0, s30, s31
  s_cmp_lt_u32 s40, 9
  s_cselect_b32 s12, s80, s82
  s_cselect_b32 s13, s81, s83
  s_cselect_b32 s31, 0, 9
  s_and_b32 s13, s13, 0xffff
  s_sub_u32 s31, s40, s31
  s_lshl_b32 s31, s31, 7
  s_add_u32 s32, s31, s53
  buffer_load_dwordx4 v12, s[12:15], s32 offen lds
  buffer_load_dwordx4 v13, s[12:15], s32 offen offset:1024 lds
  s_add_u32 s40, s40, 1
  s_cmp_lt_u32 s40, 16
  s_cbranch_scc1 L_cl_14
  s_add_u32 s32, s53, 896
  buffer_load_dwordx4 v[124:127], v12, s[12:15], s32 offen offset:0
  buffer_load_dwordx4 v[124:127], v13, s[12:15], s32 offen offset:1024
  buffer_load_dwordx4 v[124:127], v12, s[12:15], s32 offen offset:128
  buffer_load_dwordx4 v[124:127], v13, s[12:15], s32 offen offset:1152
  v_and_b32 v24, 3, v2
  v_lshlrev_b32 v24, 2, v24
  v_add_u32 v24, 159808, v24
  s_mov_b32 s33, 0
  s_mov_b32 s30, 1342177280
L_pg_15:
  ds_read_b32 v25, v24
  s_add_u32 s33, s33, 1
  s_waitcnt lgkmcnt(0)
  v_cmp_gt_u32 vcc, 159772, v25
  s_cmp_gt_u32 s33, 160000
  s_cbranch_scc1 L_pg_15x
  s_cbranch_vccz L_pg_15x
  s_sleep 8
  s_branch L_pg_15
L_pg_15x:
  s_mov_b32 s40, 7
L_cl_16:
  s_lshl_b32 s30, s40, 13
  s_add_u32 s30, s30, 0
  s_lshl_b32 s31, s51, 11
  s_add_u32 m0, s30, s31
  s_cmp_lt_u32 s40, 9
  s_cselect_b32 s12, s80, s82
  s_cselect_b32 s13, s81, s83
  s_cselect_b32 s31, 0, 9
  s_and_b32 s13, s13, 0xffff
  s_sub_u32 s31, s40, s31
  s_lshl_b32 s31, s31, 7
  s_add_u32 s32, s31, s53
  buffer_load_dwordx4 v12, s[12:15], s32 offen lds
  buffer_load_dwordx4 v13, s[12:15], s32 offen offset:1024 lds
  s_add_u32 s40, s40, 1
  s_cmp_lt_u32 s40, 9
  s_cbranch_scc1 L_cl_16
  s_branch L_hpfd
L_hpfa:
  v_lshrrev_b32 v24, 2, v2
  v_and_b32 v25, 3, v2
  v_and_b32 v26, 3, v24
  v_bfe_u32 v27, v24, 2, 1
  v_lshl_add_u32 v26, v27, 3, v26
  v_lshrrev_b32 v27, 3, v24
  v_lshl_add_u32 v26, v27, 2, v26
  v_mul_u32_u24 v26, 1152, v26
  v_lshl_add_u32 v12, v25, 4, v26
  v_lshrrev_b32 v26, 1, v24
  v_mul_u32_u24 v26, 18, v26
  v_and_b32 v27, 1, v24
  v_add3_u32 v26, v26, v27, 16
  v_mul_u32_u24 v26, 1152, v26
  v_lshl_add_u32 v13, v25, 4, v26
  s_sub_u32 s30, s38, 9
  s_mul_i32 s53, s30, 192
  s_mov_b32 s55, s51
  s_mov_b32 s12, s68
  s_and_b32 s13, s69, 0xffff
  s_mov_b32 s14, 663552
  s_mov_b32 s15, 0x20000
  v_and_b32 v24, 3, v2
  v_lshlrev_b32 v24, 2, v24
  v_add_u32 v24, 159808, v24
  s_mov_b32 s33, 0
  s_mov_b32 s30, 1342177280
L_pg_17:
  ds_read_b32 v25, v24
  s_add_u32 s33, s33, 1
  s_waitcnt lgkmcnt(0)
  v_cmp_gt_u32 vcc, 159756, v25
  s_cmp_gt_u32 s33, 160000
  s_cbranch_scc1 L_pg_17x
  s_cbranch_vccz L_pg_17x
  s_sleep 16
  s_branch L_pg_17
L_pg_17x:
  s_mov_b32 s35, 0
L_a3i_18:
  s_mul_i32 s30, s55, 3072
  s_add_u32 s31, s30, 100352
  s_sub_u32 s30, s30, 55296
  s_add_u32 s32, s55, 18
  s_sub_u32 s34, s55, 18
  s_cmp_lt_u32 s55, 18
  s_cselect_b32 s30, s31, s30
  s_cselect_b32 s32, s32, s34
  s_mul_i32 s31, s32, 20736
  v_mov_b32 v14, v12
  s_cmp_lt_u32 s32, 32
  s_cbranch_scc1 L_a3i_18m
  s_sub_u32 s32, s32, 32
  s_mul_i32 s31, s32, 165888
  v_mov_b32 v14, v13
L_a3i_18m:
  s_add_u32 s31, s31, s53
  s_add_u32 m0, s30, 0
  s_add_u32 s32, s31, 0
  buffer_load_dwordx4 v14, s[12:15], s32 offen lds
  s_add_u32 m0, s30, 1024
  s_add_u32 s32, s31, 64
  buffer_load_dwordx4 v14, s[12:15], s32 offen lds
  s_add_u32 m0, s30, 2048
  s_add_u32 s32, s31, 128
  buffer_load_dwordx4 v14, s[12:15], s32 offen lds
  s_add_u32 s55, s55, 4
  s_add_u32 s35, s35, 1
  s_cmp_lt_u32 s35, 4
  s_cbranch_scc1 L_a3i_18
  v_and_b32 v24, 3, v2
  v_lshlrev_b32 v24, 2, v24
  v_add_u32 v24, 159808, v24
  s_mov_b32 s33, 0
  s_mov_b32 s30, 1342177280
L_pg_19:
  ds_read_b32 v25, v24
  s_add_u32 s33, s33, 1
  s_waitcnt lgkmcnt(0)
  v_cmp_gt_u32 vcc, 159768, v25
  s_cmp_gt_u32 s33, 160000
  s_cbranch_scc1 L_pg_19x
  s_cbranch_vccz L_pg_19x
  s_sleep 16
  s_branch L_pg_19
L_pg_19x:
  s_mov_b32 s35, 0
L_a3i_20:
  s_mul_i32 s30, s55, 3072
  s_add_u32 s31, s30, 100352
  s_sub_u32 s30, s30, 55296
  s_add_u32 s32, s55, 18
  s_sub_u32 s34, s55, 18
  s_cmp_lt_u32 s55, 18
  s_cselect_b32 s30, s31, s30
  s_cselect_b32 s32, s32, s34
  s_mul_i32 s31, s32, 20736
  v_mov_b32 v14, v12
  s_cmp_lt_u32 s32, 32
  s_cbranch_scc1 L_a3i_20m
  s_sub_u32 s32, s32, 32
  s_mul_i32 s31, s32, 165888
  v_mov_b32 v14, v13
L_a3i_20m:
  s_add_u32 s31, s31, s53
  s_add_u32 m0, s30, 0
  s_add_u32 s32, s31, 0
  buffer_load_dwordx4 v14, s[12:15], s32 offen lds
  s_add_u32 m0, s30, 1024
  s_add_u32 s32, s31, 64
  buffer_load_dwordx4 v14, s[12:15], s32 offen lds
  s_add_u32 m0, s30, 2048
  s_add_u32 s32, s31, 128
  buffer_load_dwordx4 v14, s[12:15], s32 offen lds
  s_add_u32 s55, s55, 4
  s_add_u32 s35, s35, 1
  s_cmp_lt_u32 s35, 5
  s_cbranch_scc1 L_a3i_20
L_hpfd:
  s_waitcnt vmcnt(0)
  s_mov_b64 exec, 1
  ds_add_u32 v20, v157 offset:120
  s_mov_b64 exec, -1
L_hfin:
  s_cmp_lg_u32 s27, 0
  s_cbranch_scc1 L_hok
  v_and_b32 v24, 3, v2
  v_lshlrev_b32 v24, 2, v24
  v_add_u32 v24, 159808, v24
  s_mov_b32 s33, 0
  s_mov_b32 s30, 1342177280
L_pg_21:
  ds_read_b32 v25, v24
  s_add_u32 s33, s33, 1
  s_waitcnt lgkmcnt(0)
  v_cmp_gt_u32 vcc, 159772, v25
  s_cmp_gt_u32 s33, 160000
  s_cbranch_scc1 L_pg_21x
  s_cbranch_vccz L_pg_21x
  s_sleep 32
  s_branch L_pg_21
L_pg_21x:
  v_and_b32 v24, 3, v2
  v_lshlrev_b32 v24, 2, v24
  v_add_u32 v24, 159808, v24
  s_mov_b32 s33, 0
  s_mov_b32 s30, 1342177280
L_pg_22:
  ds_read_b32 v25, v24
  s_add_u32 s33, s33, 1
  s_waitcnt lgkmcnt(0)
  v_cmp_gt_u32 vcc, 1073741824, v25
  s_cmp_gt_u32 s33, 160000
  s_cbranch_scc1 L_pg_22x
  s_cbranch_vccz L_pg_22x
  s_sleep 4
  s_branch L_pg_22
L_pg_22x:
  v_cmp_eq_u32 vcc, s30, v25
  s_cbranch_vccnz L_hredo
L_hok:
  s_cmp_ge_u32 s21, 18
  s_cbranch_scc1 L_hopf
  s_mov_b32 s40, 16
L_cl_23:
  s_lshl_b32 s30, s40, 13
  s_add_u32 s30, s30, 4294909952
  s_lshl_b32 s31, s51, 11
  s_add_u32 m0, s30, s31
  s_cmp_lt_u32 s40, 9
  s_cselect_b32 s12, s80, s82
  s_cselect_b32 s13, s81, s83
  s_cselect_b32 s31, 0, 9
  s_and_b32 s13, s13, 0xffff
  s_sub_u32 s31, s40, s31
  s_lshl_b32 s31, s31, 7
  s_add_u32 s32, s31, s53
  buffer_load_dwordx4 v12, s[12:15], s32 offen lds
  buffer_load_dwordx4 v13, s[12:15], s32 offen offset:1024 lds
  s_add_u32 s40, s40, 1
  s_cmp_lt_u32 s40, 18
  s_cbranch_scc1 L_cl_23
  s_lshl_b32 s34, s27, 2
  s_add_u32 s34, s34, 4
  s_setprio 3
  s_branch L_b3main
L_hopf:
  s_branch L_exit
L_hredo:
  s_mov_b32 s27, 1
  s_waitcnt vmcnt(0) lgkmcnt(0)
  s_barrier
  s_lshr_b32 s30, s39, 1
  s_mul_i32 s30, s30, 9
  s_and_b32 s31, s39, 1
  s_lshl_b32 s31, s31, 2
  s_add_u32 s36, s30, s31
  s_add_u32 s30, s36, s51
  s_lshl_b32 s30, s30, 10
  s_mul_i32 s31, 0, 591872
  s_add_u32 s30, s30, s31
  s_add_u32 s52, s30, 147456
  s_cmp_eq_u32 s51, 0
  s_cselect_b32 s54, 0, 290816
  s_add_u32 s54, s54, 4096
  s_mul_i32 s30, s39, 288
  s_mul_i32 s31, s51, 28032
  s_add_u32 s30, s30, s31
  s_mul_i32 s31, 0, 299008
  s_add_u32 s30, s30, s31
  s_add_u32 s55, s30, 5242880
  v_mul_u32_u24 v24, 27, v2
  v_lshrrev_b32 v24, 9, v24
  v_mul_u32_u24 v22, 19, v24
  v_sub_u32 v22, v2, v22
  v_cmp_gt_u32 vcc, 18, v22
  v_cmp_gt_u32 s[58:59], 3, v24
  v_cmp_gt_u32 s[60:61], 2, v24
  v_mul_u32_u24 v24, 9344, v24
  v_lshl_add_u32 v22, v22, 4, v24
  s_and_b64 s[58:59], s[58:59], vcc
  s_and_b64 s[60:61], s[60:61], vcc
  s_cmp_eq_u32 s51, 2
  s_cselect_b64 s[60:61], s[60:61], s[58:59]
  s_add_u32 s30, 0, 5
  s_and_b32 s30, s30, 7
  s_mul_i32 s56, s30, 19968
  v_mul_u32_u24 v23, 304, v1
  v_add_u32 v23, 10528, v23
  s_mov_b32 s35, 0
L_hredo1:
  s_lshl_b32 s31, s51, 10
  s_add_u32 s31, s31, s56
  s_mov_b32 m0, s31
  s_add_u32 s30, s52, s54
  buffer_load_dwordx4 v3, s[4:7], s52 offen sc0 sc1 lds
  s_add_u32 m0, s31, 4096
  s_cmp_ge_u32 s51, 2
  buffer_load_dwordx4 v3, s[4:7], s30 offen sc0 sc1 lds
  s_cbranch_scc1 L_kd_24
  s_add_u32 m0, s31, 8192
  s_add_u32 s30, s52, 299008
  buffer_load_dwordx4 v3, s[4:7], s30 offen sc0 sc1 lds
L_kd_24:
  s_mul_i32 s31, s51, 912
  s_add_u32 s31, s31, s56
  s_add_u32 m0, s31, 10240
  s_mov_b64 exec, s[58:59]
  buffer_load_dwordx4 v22, s[4:7], s55 offen sc0 sc1 lds
  s_add_u32 m0, s31, 13888
  s_add_u32 s30, s55, 112128
  buffer_load_dwordx4 v22, s[4:7], s30 offen sc0 sc1 lds
  s_cmp_eq_u32 s51, 3
  s_cbranch_scc1 L_vd_25
  s_add_u32 m0, s31, 17536
  s_add_u32 s30, s55, 224256
  s_mov_b64 exec, s[60:61]
  buffer_load_dwordx4 v22, s[4:7], s30 offen sc0 sc1 lds
L_vd_25:
  s_mov_b64 exec, -1
  v_add_u32 v24, s56, v23
  ds_write_b128 v24, v[16:19]
  s_add_u32 s52, s52, 591872
  s_add_u32 s55, s55, 299008
  s_add_u32 s56, s56, 19968
  s_cmp_eq_u32 s56, 159744
  s_cselect_b32 s56, 0, s56
  s_add_u32 s35, s35, 1
  s_cmp_lt_u32 s35, 8
  s_cbranch_scc1 L_hredo1
  s_waitcnt vmcnt(0) lgkmcnt(0)
  s_barrier
  s_barrier
  s_branch L_hpf
L_attshare:
  s_mov_b32 s40, 1
  s_add_u32 s31, s40, s28
  s_sub_u32 s30, s31, 9
  s_cmp_ge_u32 s31, 9
  s_cselect_b32 s31, s30, s31
  s_lshl_b32 s31, s31, 7
  s_and_b32 s18, s40, 3
  s_mul_i32 s18, s18, 24576
  s_add_u32 s18, s18, 0
  s_lshl_b32 s30, s51, 12
  s_add_u32 m0, s30, s18
  s_add_u32 s32, s31, s16
  buffer_load_dwordx4 v60, s[8:11], s32 offen offset:0 lds
  buffer_load_dwordx4 v61, s[8:11], s32 offen offset:1024 lds
  buffer_load_dwordx4 v62, s[8:11], s32 offen offset:2048 lds
  buffer_load_dwordx4 v63, s[8:11], s32 offen offset:3072 lds
  s_lshl_b32 s30, s51, 11
  s_add_u32 s30, s30, s18
  s_add_u32 m0, s30, 16384
  s_add_u32 s32, s31, s17
  buffer_load_dwordx4 v64, s[12:15], s32 offen offset:0 lds
  buffer_load_dwordx4 v65, s[12:15], s32 offen offset:1024 lds
  s_mov_b32 s40, 3
  s_add_u32 s31, s40, s28
  s_sub_u32 s30, s31, 9
  s_cmp_ge_u32 s31, 9
  s_cselect_b32 s31, s30, s31
  s_lshl_b32 s31, s31, 7
  s_and_b32 s18, s40, 3
  s_mul_i32 s18, s18, 24576
  s_add_u32 s18, s18, 0
  s_lshl_b32 s30, s51, 12
  s_add_u32 m0, s30, s18
  s_add_u32 s32, s31, s16
  buffer_load_dwordx4 v60, s[8:11], s32 offen offset:0 lds
  buffer_load_dwordx4 v61, s[8:11], s32 offen offset:1024 lds
  buffer_load_dwordx4 v62, s[8:11], s32 offen offset:2048 lds
  buffer_load_dwordx4 v63, s[8:11], s32 offen offset:3072 lds
  s_lshl_b32 s30, s51, 11
  s_add_u32 s30, s30, s18
  s_add_u32 m0, s30, 16384
  s_add_u32 s32, s31, s17
  buffer_load_dwordx4 v64, s[12:15], s32 offen offset:0 lds
  buffer_load_dwordx4 v65, s[12:15], s32 offen offset:1024 lds
  s_lshr_b32 s30, s39, 1
  s_mul_i32 s30, s30, 9
  s_and_b32 s31, s39, 1
  s_lshl_b32 s31, s31, 2
  s_add_u32 s36, s30, s31
  s_add_u32 s30, s36, s51
  s_lshl_b32 s30, s30, 10
  s_mul_i32 s31, 0, 591872
  s_add_u32 s30, s30, s31
  s_add_u32 s52, s30, 147456
  s_cmp_eq_u32 s51, 0
  s_cselect_b32 s54, 0, 290816
  s_add_u32 s54, s54, 4096
  s_mul_i32 s30, s39, 288
  s_mul_i32 s31, s51, 28032
  s_add_u32 s30, s30, s31
  s_mul_i32 s31, 0, 299008
  s_add_u32 s30, s30, s31
  s_add_u32 s55, s30, 5242880
  v_mul_u32_u24 v18, 27, v2
  v_lshrrev_b32 v18, 9, v18
  v_mul_u32_u24 v146, 19, v18
  v_sub_u32 v146, v2, v146
  v_cmp_gt_u32 vcc, 18, v146
  v_cmp_gt_u32 s[58:59], 3, v18
  v_cmp_gt_u32 s[60:61], 2, v18
  v_mul_u32_u24 v18, 9344, v18
  v_lshl_add_u32 v146, v146, 4, v18
  s_and_b64 s[58:59], s[58:59], vcc
  s_and_b64 s[60:61], s[60:61], vcc
  s_cmp_eq_u32 s51, 2
  s_cselect_b64 s[60:61], s[60:61], s[58:59]
  s_add_u32 s30, 0, 5
  s_and_b32 s30, s30, 7
  s_mul_i32 s56, s30, 19968
  v_mul_u32_u24 v147, 304, v1
  v_add_u32 v147, 10528, v147
  s_lshr_b32 s29, s21, 2
  s_lshl_b32 s29, s29, 3
  s_lshl_b32 s30, s51, 1
  s_add_u32 s29, s29, s30
  s_lshr_b32 s32, s29, 2
  s_mul_i32 s32, s32, 289
  s_add_u32 s32, s32, s36
  s_lshl_b32 s32, s32, 10
  s_and_b32 s30, s29, 3
  s_lshl_b32 s30, s30, 8
  s_add_u32 s32, s32, s30
  s_add_u32 s35, s32, 0
  s_and_b32 s33, s39, 1
  v_lshrrev_b32 v19, 5, v2
  v_lshlrev_b32 v18, 3, v1
  v_lshl_add_u32 v140, v19, 11, v18
  s_lshl_b32 s30, s33, 10
  v_add_u32 v140, s30, v140
  s_mul_i32 s31, s33, 4092
  s_sub_u32 s31, 4096, s31
  v_add_u32 v142, s31, v18
  v_lshl_add_u32 v17, v2, 3, s31
  v_min_u32 v16, 18, v1
  v_mul_u32_u24 v19, 304, v19
  v_lshl_add_u32 v141, v16, 4, v19
  v_add_u32 v141, 110080, v141
  v_cmp_lt_u32 vcc, 18, v1
  v_cmp_ne_u32 s[30:31], 28, v1
  s_and_b64 vcc, vcc, s[30:31]
  v_mov_b32 v19, 0x100000
  v_mov_b32 v14, 0xdddd
  v_cndmask_b32 v141, v141, v19, vcc
  v_mov_b32 v24, 0x3f803f80
  v_mov_b32 v25, 0x3f803f80
  v_mov_b32 v26, 0x3f803f80
  v_mov_b32 v27, 0x3f803f80
  s_lshl_b32 s30, s51, 2
  s_add_u32 s30, s30, 159808
  v_mov_b32 v145, s30
  s_mov_b32 s62, 0
  s_mov_b32 s63, -1
  s_mov_b32 s47, 0
  s_mov_b32 s48, 1
  s_mov_b32 s49, 99840
  s_waitcnt vmcnt(6)
  s_mov_b64 exec, 1
  ds_add_u32 v66, v67 offset:4
  s_mov_b64 exec, -1
  s_waitcnt vmcnt(0)
  s_mov_b64 exec, 1
  ds_add_u32 v66, v67 offset:12
  s_mov_b64 exec, -1
  s_mov_b32 s33, 0
L_sp_26:
  ds_read_b32 v68, v66 offset:260
  s_add_u32 s33, s33, 1
  s_waitcnt lgkmcnt(0)
  v_readfirstlane_b32 s32, v68
  s_cmp_ge_u32 s32, 4
  s_cbranch_scc1 L_sp_26x
  s_cmp_lt_u32 s33, 320000
  s_cbranch_scc1 L_sp_26
L_sp_26x:
  s_mov_b32 s40, 5
  s_add_u32 s31, s40, s28
  s_sub_u32 s30, s31, 9
  s_cmp_ge_u32 s31, 9
  s_cselect_b32 s31, s30, s31
  s_lshl_b32 s31, s31, 7
  s_and_b32 s18, s40, 3
  s_mul_i32 s18, s18, 24576
  s_add_u32 s18, s18, 0
  s_lshl_b32 s30, s51, 12
  s_add_u32 m0, s30, s18
  s_add_u32 s32, s31, s16
  buffer_load_dwordx4 v60, s[8:11], s32 offen offset:0 lds
  buffer_load_dwordx4 v61, s[8:11], s32 offen offset:1024 lds
  buffer_load_dwordx4 v62, s[8:11], s32 offen offset:2048 lds
  buffer_load_dwordx4 v63, s[8:11], s32 offen offset:3072 lds
  s_lshl_b32 s30, s51, 11
  s_add_u32 s30, s30, s18
  s_add_u32 m0, s30, 16384
  s_add_u32 s32, s31, s17
  buffer_load_dwordx4 v64, s[12:15], s32 offen offset:0 lds
  buffer_load_dwordx4 v65, s[12:15], s32 offen offset:1024 lds
  v_mov_b32 v69, 0
  s_cmp_lg_u32 s3, 4
  s_cbranch_scc1 L_as1
  v_mov_b32 v70, 159856
  ds_read_b32 v68, v70
  s_mul_i32 s34, s39, 1024
  s_add_u32 s34, s34, 17843200
  v_and_b32 v70, 7, v2
  v_lshlrev_b32 v70, 7, v70
  s_waitcnt lgkmcnt(0)
  v_readfirstlane_b32 s32, v68
  s_cmp_eq_u32 s32, 0
  s_cbranch_scc1 L_as1
  buffer_load_dword v69, v70, s[4:7], s34 offen sc0 sc1
  s_waitcnt vmcnt(1)
  s_branch L_as2
L_as1:
  s_waitcnt vmcnt(0)
L_as2:
  s_mov_b64 exec, 1
  ds_add_u32 v66, v67 offset:20
  s_mov_b64 exec, -1
  v_mov_b32 v78, 159852
  s_cmp_lg_u32 s3, 4
  s_cbranch_scc1 L_pollF1a_w
  s_waitcnt vmcnt(0)
  v_cmp_ne_u32 vcc, 108, v69
  s_cbranch_vccz L_pollF1a_x
  v_mov_b32 v76, 159856
  s_mov_b32 s33, 0
L_sp_27:
  ds_read_b32 v77, v76 offset:0
  s_add_u32 s33, s33, 1
  s_waitcnt lgkmcnt(0)
  v_readfirstlane_b32 s32, v77
  s_cmp_ge_u32 s32, 1
  s_cbranch_scc1 L_sp_27x
  s_sleep 2
  s_cmp_lt_u32 s33, 320000
  s_cbranch_scc1 L_sp_27
L_sp_27x:
  s_mul_i32 s34, s39, 1024
  s_add_u32 s34, s34, 17843200
  v_and_b32 v76, 7, v2
  v_lshlrev_b32 v76, 7, v76
  s_mov_b32 s33, 0
L_pollF1a:
  buffer_load_dword v77, v76, s[4:7], s34 offen sc0 sc1
  s_waitcnt vmcnt(0)
  v_cmp_ne_u32 vcc, 108, v77
  s_add_u32 s33, s33, 1
  s_cmp_gt_u32 s33, 20000
  s_cbranch_scc1 L_pollF1a_x
  s_cbranch_vccz L_pollF1a_x
  s_sleep 4
  s_branch L_pollF1a
L_pollF1a_x:
  v_mov_b32 v76, 1
  ds_write_b32 v78, v76
L_pollF1a_w:
  s_mov_b32 s33, 0
L_sp_28:
  ds_read_b32 v77, v78 offset:0
  s_add_u32 s33, s33, 1
  s_waitcnt lgkmcnt(0)
  v_readfirstlane_b32 s32, v77
  s_cmp_ge_u32 s32, 1
  s_cbranch_scc1 L_sp_28x
  s_sleep 1
  s_cmp_lt_u32 s33, 320000
  s_cbranch_scc1 L_sp_28
L_sp_28x:
  s_setprio 3
  s_lshl_b32 s31, s51, 10
  s_add_u32 s31, s31, s56
  s_mov_b32 m0, s31
  s_add_u32 s30, s52, s54
  buffer_load_dwordx4 v3, s[4:7], s52 offen sc0 sc1 lds
  s_add_u32 m0, s31, 4096
  s_cmp_ge_u32 s51, 2
  buffer_load_dwordx4 v3, s[4:7], s30 offen sc0 sc1 lds
  s_cbranch_scc1 L_kd_29
  s_add_u32 m0, s31, 8192
  s_add_u32 s30, s52, 299008
  buffer_load_dwordx4 v3, s[4:7], s30 offen sc0 sc1 lds
L_kd_29:
  buffer_load_dwordx2 v[4:5], v140, s[4:7], s35 offen offset:0 sc0 sc1
  buffer_load_dwordx2 v[6:7], v140, s[4:7], s35 offen offset:1024 sc0 sc1
  buffer_load_dwordx2 v[8:9], v140, s[4:7], s35 offen offset:256 sc0 sc1
  buffer_load_dwordx2 v[10:11], v140, s[4:7], s35 offen offset:1280 sc0 sc1
  buffer_load_dword v12, v17, s[4:7], s35 offen sc0 sc1
  s_mul_i32 s31, s51, 912
  s_add_u32 s31, s31, s56
  s_add_u32 m0, s31, 10240
  s_mov_b64 exec, s[58:59]
  buffer_load_dwordx4 v146, s[4:7], s55 offen sc0 sc1 lds
  s_add_u32 m0, s31, 13888
  s_add_u32 s30, s55, 112128
  buffer_load_dwordx4 v146, s[4:7], s30 offen sc0 sc1 lds
  s_cmp_eq_u32 s51, 3
  s_cbranch_scc1 L_vd_30
  s_add_u32 m0, s31, 17536
  s_add_u32 s30, s55, 224256
  s_mov_b64 exec, s[60:61]
  buffer_load_dwordx4 v146, s[4:7], s30 offen sc0 sc1 lds
L_vd_30:
  s_mov_b64 exec, -1
  v_add_u32 v18, s56, v147
  ds_write_b128 v18, v[24:27]
  s_add_u32 s52, s52, 591872
  s_add_u32 s55, s55, 299008
  s_add_u32 s56, s56, 19968
  s_cmp_eq_u32 s56, 159744
  s_cselect_b32 s56, 0, s56
  s_lshl_b32 s31, s51, 10
  s_add_u32 s31, s31, s56
  s_mov_b32 m0, s31
  s_add_u32 s30, s52, s54
  buffer_load_dwordx4 v3, s[4:7], s52 offen sc0 sc1 lds
  s_add_u32 m0, s31, 4096
  s_cmp_ge_u32 s51, 2
  buffer_load_dwordx4 v3, s[4:7], s30 offen sc0 sc1 lds
  s_cbranch_scc1 L_kd_31
  s_add_u32 m0, s31, 8192
  s_add_u32 s30, s52, 299008
  buffer_load_dwordx4 v3, s[4:7], s30 offen sc0 sc1 lds
L_kd_31:
  s_mul_i32 s31, s51, 912
  s_add_u32 s31, s31, s56
  s_add_u32 m0, s31, 10240
  s_mov_b64 exec, s[58:59]
  buffer_load_dwordx4 v146, s[4:7], s55 offen sc0 sc1 lds
  s_add_u32 m0, s31, 13888
  s_add_u32 s30, s55, 112128
  buffer_load_dwordx4 v146, s[4:7], s30 offen sc0 sc1 lds
  s_cmp_eq_u32 s51, 3
  s_cbranch_scc1 L_vd_32
  s_add_u32 m0, s31, 17536
  s_add_u32 s30, s55, 224256
  s_mov_b64 exec, s[60:61]
  buffer_load_dwordx4 v146, s[4:7], s30 offen sc0 sc1 lds
L_vd_32:
  s_mov_b64 exec, -1
  v_add_u32 v18, s56, v147
  ds_write_b128 v18, v[24:27]
  v_mov_b32 v143, 159744
  v_mov_b32 v144, 1
  s_waitcnt vmcnt(6)
  s_mov_b64 exec, 1
  ds_add_u32 v143, v144 offset:140
  s_mov_b64 exec, -1
  s_mov_b32 s33, 0
L_sp_33:
  ds_read_b32 v18, v143 offset:140
  s_add_u32 s33, s33, 1
  s_waitcnt lgkmcnt(0)
  v_readfirstlane_b32 s32, v18
  s_cmp_ge_u32 s32, 4
  s_cbranch_scc1 L_sp_33x
  s_cmp_lt_u32 s33, 320000
  s_cbranch_scc1 L_sp_33
L_sp_33x:
L_maxpass:
  v_add_u32 v15, s49, v140
  v_add_u32 v17, s49, v142
  v_mov_b32 v13, 0
  v_mov_b32 v18, 0xff800000
  v_mov_b32 v19, 0xff800000
  s_mov_b32 s50, 0
L_maxloop:
  ds_read_b32 v24, v17 offset:0
  ds_read2st64_b64 v[20:23], v15 offset0:0 offset1:2
  s_mov_b32 s30, 256
  s_and_b32 s31, s50, 3
  s_cmp_eq_u32 s31, 3
  s_cselect_b32 s30, 4352, s30
  s_and_b32 s31, s50, 7
  s_cmp_eq_u32 s31, 7
  s_cselect_b32 s30, 14080, s30
  s_add_u32 s50, s50, 1
  s_waitcnt lgkmcnt(0)
  v_mfma_f32_32x32x4_2b_bf16 v[76:107], v[24:25], v[12:13], 0
  v_add_u32 v15, s30, v15
  v_add_u32 v17, s30, v17
  v_mov_b32 v44, 0
  v_mov_b32 v45, 0
  v_mov_b32 v46, 0
  v_mov_b32 v47, 0
  v_mov_b32 v48, 0
  v_mov_b32 v49, 0
  v_mov_b32 v50, 0
  v_mov_b32 v51, 0
  v_mov_b32 v52, 0
  v_mov_b32 v53, 0
  v_mov_b32 v54, 0
  v_mov_b32 v55, 0
  v_mov_b32 v56, 0
  v_mov_b32 v57, 0
  v_mov_b32 v58, 0
  v_mov_b32 v59, 0
  v_mfma_f32_32x32x16_bf16 v[76:91], v[20:23], v[4:7], v[76:91]
  v_mfma_f32_32x32x16_bf16 v[92:107], v[20:23], v[8:11], v[92:107]
  v_mov_b32 v60, 0
  v_mov_b32 v61, 0
  v_mov_b32 v62, 0
  v_mov_b32 v63, 0
  v_mov_b32 v64, 0
  v_mov_b32 v65, 0
  v_mov_b32 v66, 0
  v_mov_b32 v67, 0
  v_mov_b32 v68, 0
  v_mov_b32 v69, 0
  v_mov_b32 v70, 0
  v_mov_b32 v71, 0
  v_mov_b32 v72, 0
  v_mov_b32 v73, 0
  v_mov_b32 v74, 0
  v_mov_b32 v75, 0
  v_max3_f32 v18, v76, v77, v18
  v_max3_f32 v19, v92, v93, v19
  v_max3_f32 v18, v78, v79, v18
  v_max3_f32 v19, v94, v95, v19
  v_max3_f32 v18, v80, v81, v18
  v_max3_f32 v19, v96, v97, v19
  v_max3_f32 v18, v82, v83, v18
  v_max3_f32 v19, v98, v99, v19
  v_max3_f32 v18, v84, v85, v18
  v_max3_f32 v19, v100, v101, v19
  v_max3_f32 v18, v86, v87, v18
  v_max3_f32 v19, v102, v103, v19
  v_max3_f32 v18, v88, v89, v18
  v_max3_f32 v19, v104, v105, v19
  v_max3_f32 v18, v90, v91, v18
  v_max3_f32 v19, v106, v107, v19
  s_cmp_lt_u32 s50, s48
  s_cbranch_scc1 L_maxloop
  v_add_u32 v15, 99840, v140
  v_add_u32 v17, 99840, v142
  v_mov_b32 v16, v141
  v_add_u32 v151, 256, v15
  ds_read_b32 v24, v17 offset:0
  ds_read2st64_b64 v[20:23], v15 offset0:0 offset1:2
  ds_read_b32 v26, v17 offset:256
  ds_read2st64_b64 v[152:155], v151 offset0:0 offset1:2
  v_permlane32_swap_b32 v18, v19
  s_mov_b32 s43, 4294827520
  s_mov_b32 s44, 0
  v_max_f32 v19, v18, v19
  v_cvt_pk_bf16_f32 v18, -v19, 0
  v_lshlrev_b32 v18, 16, v18
  v_sub_f32 v18, -v19, v18
  v_cvt_pk_bf16_f32 v13, -v19, v18
  v_mov_b32 v143, 159744
  v_mov_b32 v19, 1
  s_waitcnt lgkmcnt(2)
  v_mfma_f32_32x32x4_2b_bf16 v[76:107], v[24:25], v[12:13], 0
  s_cmp_lg_u32 s47, 0
  s_cbranch_scc1 L_nl0
  s_waitcnt vmcnt(4)
  s_mov_b64 exec, 1
  ds_add_u32 v143, v19 offset:0
  s_mov_b64 exec, -1
L_nl0:
  v_mov_b32 v132, 0
  v_mov_b32 v133, 0
  v_mov_b32 v134, 0
  v_mov_b32 v135, 0
  v_mov_b32 v136, 0
  v_mov_b32 v137, 0
  v_mov_b32 v138, 0
  v_mov_b32 v139, 0
  v_mov_b32 v40, 0
  v_mov_b32 v41, 0
  v_mov_b32 v42, 0
  v_mov_b32 v43, 0
  s_nop 3
  v_mfma_f32_32x32x16_bf16 v[76:91], v[20:23], v[4:7], v[76:91]
  v_mfma_f32_32x32x16_bf16 v[92:107], v[20:23], v[8:11], v[92:107]
  s_mov_b32 s33, 0
L_sp_34:
  ds_read_b32 v18, v143 offset:0
  s_add_u32 s33, s33, 1
  s_waitcnt lgkmcnt(0)
  v_readfirstlane_b32 s32, v18
  s_cmp_ge_u32 s32, 4
  s_cbranch_scc1 L_sp_34x
  s_cmp_lt_u32 s33, 320000
  s_cbranch_scc1 L_sp_34
L_sp_34x:
  ds_read_b128 v[28:31], v16 offset:0
  ds_read_b128 v[32:35], v16 offset:608
  s_nop 2
.p2align 6
L_loop:
  v_exp_f32 v76, v76
  v_exp_f32 v77, v77
  v_smfmac_f32_32x32x32_bf16 v[60:75], v[40:43], v[132:139], v14
  ds_read_b128 v[36:39], v16 offset:1216
  s_waitcnt lgkmcnt(1)
  v_exp_f32 v78, v78
  v_exp_f32 v79, v79
  v_exp_f32 v80, v80
  v_exp_f32 v81, v81
  v_mfma_f32_32x32x4_2b_bf16 v[108:139], v[26:27], v[12:13], 0
  ds_read_b128 v[40:43], v16 offset:1824
  s_cmp_eq_u32 s44, 2
  s_cselect_b32 s45, s43, 19968
  v_exp_f32 v82, v82
  v_exp_f32 v83, v83
  v_exp_f32 v84, v84
  v_exp_f32 v85, v85
  v_exp_f32 v86, v86
  v_exp_f32 v87, v87
  v_exp_f32 v88, v88
  v_exp_f32 v89, v89
  v_smfmac_f32_32x32x32_bf16 v[44:59], v[28:31], v[76:83], v14
  ds_read_b32 v24, v17 offset:512
  v_exp_f32 v90, v90
  v_exp_f32 v91, v91
  v_exp_f32 v92, v92
  v_exp_f32 v93, v93
  v_smfmac_f32_32x32x32_bf16 v[44:59], v[32:35], v[84:91], v14
  ds_read2st64_b64 v[20:23], v15 offset0:1 offset1:3
  v_exp_f32 v94, v94
  v_exp_f32 v95, v95
  v_exp_f32 v96, v96
  v_exp_f32 v97, v97
  v_mfma_f32_32x32x16_bf16 v[108:123], v[152:155], v[4:7], v[108:123]
  v_exp_f32 v98, v98
  v_exp_f32 v99, v99
  v_exp_f32 v100, v100
  v_exp_f32 v101, v101
  v_smfmac_f32_32x32x32_bf16 v[60:75], v[28:31], v[92:99], v14
  v_exp_f32 v102, v102
  v_exp_f32 v103, v103
  v_exp_f32 v104, v104
  v_exp_f32 v105, v105
  v_mfma_f32_32x32x16_bf16 v[124:139], v[152:155], v[8:11], v[124:139]
  v_exp_f32 v106, v106
  v_exp_f32 v107, v107
  v_exp_f32 v108, v108
  v_exp_f32 v109, v109
  v_smfmac_f32_32x32x32_bf16 v[60:75], v[32:35], v[100:107], v14
  ds_read_b128 v[28:31], v16 offset:2432
  s_waitcnt lgkmcnt(1)
  v_exp_f32 v110, v110
  v_exp_f32 v111, v111
  v_exp_f32 v112, v112
  v_exp_f32 v113, v113
  v_mfma_f32_32x32x4_2b_bf16 v[76:107], v[24:25], v[12:13], 0
  ds_read_b128 v[32:35], v16 offset:3040
  ds_write_b32 v145, v143
  v_exp_f32 v114, v114
  v_exp_f32 v115, v115
  v_exp_f32 v116, v116
  v_exp_f32 v117, v117
  v_exp_f32 v118, v118
  v_exp_f32 v119, v119
  v_exp_f32 v120, v120
  v_exp_f32 v121, v121
  v_smfmac_f32_32x32x32_bf16 v[44:59], v[36:39], v[108:115], v14
  ds_read_b32 v26, v17 offset:768
  v_exp_f32 v122, v122
  v_exp_f32 v123, v123
  v_exp_f32 v124, v124
  v_exp_f32 v125, v125
  v_smfmac_f32_32x32x32_bf16 v[44:59], v[40:43], v[116:123], v14
  ds_read2st64_b64 v[152:155], v151 offset0:1 offset1:3
  v_exp_f32 v126, v126
  v_exp_f32 v127, v127
  v_exp_f32 v128, v128
  v_exp_f32 v129, v129
  v_mfma_f32_32x32x16_bf16 v[76:91], v[20:23], v[4:7], v[76:91]
  v_exp_f32 v130, v130
  v_exp_f32 v131, v131
  v_exp_f32 v132, v132
  v_exp_f32 v133, v133
  v_smfmac_f32_32x32x32_bf16 v[60:75], v[36:39], v[124:131], v14
  v_exp_f32 v134, v134
  v_exp_f32 v135, v135
  v_exp_f32 v136, v136
  v_exp_f32 v137, v137
  v_mfma_f32_32x32x16_bf16 v[92:107], v[20:23], v[8:11], v[92:107]
  v_exp_f32 v138, v138
  v_exp_f32 v139, v139
  v_exp_f32 v76, v76
  v_exp_f32 v77, v77
  v_smfmac_f32_32x32x32_bf16 v[60:75], v[40:43], v[132:139], v14
  ds_read_b128 v[36:39], v16 offset:3648
  s_waitcnt lgkmcnt(1)
  v_exp_f32 v78, v78
  v_exp_f32 v79, v79
  v_exp_f32 v80, v80
  v_exp_f32 v81, v81
  v_mfma_f32_32x32x4_2b_bf16 v[108:139], v[26:27], v[12:13], 0
  ds_read_b128 v[40:43], v16 offset:4256
  v_exp_f32 v82, v82
  v_exp_f32 v83, v83
  v_exp_f32 v84, v84
  v_exp_f32 v85, v85
  v_exp_f32 v86, v86
  v_exp_f32 v87, v87
  v_exp_f32 v88, v88
  v_exp_f32 v89, v89
  v_smfmac_f32_32x32x32_bf16 v[44:59], v[28:31], v[76:83], v14
  ds_read_b32 v24, v17 offset:5120
  v_exp_f32 v90, v90
  v_exp_f32 v91, v91
  v_exp_f32 v92, v92
  v_exp_f32 v93, v93
  v_smfmac_f32_32x32x32_bf16 v[44:59], v[32:35], v[84:91], v14
  ds_read2st64_b64 v[20:23], v15 offset0:10 offset1:12
  v_exp_f32 v94, v94
  v_exp_f32 v95, v95
  v_exp_f32 v96, v96
  v_exp_f32 v97, v97
  v_mfma_f32_32x32x16_bf16 v[108:123], v[152:155], v[4:7], v[108:123]
  v_exp_f32 v98, v98
  v_exp_f32 v99, v99
  v_exp_f32 v100, v100
  v_exp_f32 v101, v101
  v_smfmac_f32_32x32x32_bf16 v[60:75], v[28:31], v[92:99], v14
  v_exp_f32 v102, v102
  v_exp_f32 v103, v103
  v_exp_f32 v104, v104
  v_exp_f32 v105, v105
  v_mfma_f32_32x32x16_bf16 v[124:139], v[152:155], v[8:11], v[124:139]
  v_exp_f32 v106, v106
  v_exp_f32 v107, v107
  v_exp_f32 v108, v108
  v_exp_f32 v109, v109
  v_smfmac_f32_32x32x32_bf16 v[60:75], v[32:35], v[100:107], v14
  ds_read_b128 v[28:31], v16 offset:4864
  s_waitcnt lgkmcnt(1)
  v_exp_f32 v110, v110
  v_exp_f32 v111, v111
  v_exp_f32 v112, v112
  v_exp_f32 v113, v113
  v_mfma_f32_32x32x4_2b_bf16 v[76:107], v[24:25], v[12:13], 0
  ds_read_b128 v[32:35], v16 offset:5472
  s_cmp_eq_u32 s44, s47
  s_cbranch_scc1 L_sig1
L_sig1r:
  v_exp_f32 v114, v114
  v_exp_f32 v115, v115
  v_exp_f32 v116, v116
  v_exp_f32 v117, v117
  v_exp_f32 v118, v118
  v_exp_f32 v119, v119
  v_exp_f32 v120, v120
  v_exp_f32 v121, v121
  v_smfmac_f32_32x32x32_bf16 v[44:59], v[36:39], v[108:115], v14
  ds_read_b32 v26, v17 offset:5376
  v_exp_f32 v122, v122
  v_exp_f32 v123, v123
  v_exp_f32 v124, v124
  v_exp_f32 v125, v125
  v_smfmac_f32_32x32x32_bf16 v[44:59], v[40:43], v[116:123], v14
  ds_read2st64_b64 v[152:155], v151 offset0:10 offset1:12
  v_exp_f32 v126, v126
  v_exp_f32 v127, v127
  v_exp_f32 v128, v128
  v_exp_f32 v129, v129
  v_mfma_f32_32x32x16_bf16 v[76:91], v[20:23], v[4:7], v[76:91]
  v_exp_f32 v130, v130
  v_exp_f32 v131, v131
  v_exp_f32 v132, v132
  v_exp_f32 v133, v133
  v_smfmac_f32_32x32x32_bf16 v[60:75], v[36:39], v[124:131], v14
  v_exp_f32 v134, v134
  v_exp_f32 v135, v135
  v_exp_f32 v136, v136
  v_exp_f32 v137, v137
  v_mfma_f32_32x32x16_bf16 v[92:107], v[20:23], v[8:11], v[92:107]
  v_exp_f32 v138, v138
  v_exp_f32 v139, v139
  v_exp_f32 v76, v76
  v_exp_f32 v77, v77
  v_smfmac_f32_32x32x32_bf16 v[60:75], v[40:43], v[132:139], v14
  ds_read_b128 v[36:39], v16 offset:6080
  s_waitcnt lgkmcnt(1)
  v_exp_f32 v78, v78
  v_exp_f32 v79, v79
  v_exp_f32 v80, v80
  v_exp_f32 v81, v81
  v_mfma_f32_32x32x4_2b_bf16 v[108:139], v[26:27], v[12:13], 0
  ds_read_b128 v[40:43], v16 offset:6688
  v_exp_f32 v82, v82
  v_exp_f32 v83, v83
  v_exp_f32 v84, v84
  v_exp_f32 v85, v85
  v_exp_f32 v86, v86
  v_exp_f32 v87, v87
  v_exp_f32 v88, v88
  v_exp_f32 v89, v89
  v_smfmac_f32_32x32x32_bf16 v[44:59], v[28:31], v[76:83], v14
  ds_read_b32 v24, v17 offset:5632
  v_exp_f32 v90, v90
  v_exp_f32 v91, v91
  v_exp_f32 v92, v92
  v_exp_f32 v93, v93
  v_smfmac_f32_32x32x32_bf16 v[44:59], v[32:35], v[84:91], v14
  ds_read2st64_b64 v[20:23], v15 offset0:11 offset1:13
  v_exp_f32 v94, v94
  v_exp_f32 v95, v95
  v_exp_f32 v96, v96
  v_exp_f32 v97, v97
  v_mfma_f32_32x32x16_bf16 v[108:123], v[152:155], v[4:7], v[108:123]
  v_exp_f32 v98, v98
  v_exp_f32 v99, v99
  v_exp_f32 v100, v100
  v_exp_f32 v101, v101
  v_smfmac_f32_32x32x32_bf16 v[60:75], v[28:31], v[92:99], v14
  v_exp_f32 v102, v102
  v_exp_f32 v103, v103
  v_exp_f32 v104, v104
  v_exp_f32 v105, v105
  v_mfma_f32_32x32x16_bf16 v[124:139], v[152:155], v[8:11], v[124:139]
  v_exp_f32 v106, v106
  v_exp_f32 v107, v107
  v_exp_f32 v108, v108
  v_exp_f32 v109, v109
  v_smfmac_f32_32x32x32_bf16 v[60:75], v[32:35], v[100:107], v14
  ds_read_b128 v[28:31], v16 offset:7296
  s_waitcnt lgkmcnt(1)
  v_exp_f32 v110, v110
  v_exp_f32 v111, v111
  v_exp_f32 v112, v112
  v_exp_f32 v113, v113
  v_mfma_f32_32x32x4_2b_bf16 v[76:107], v[24:25], v[12:13], 0
  ds_read_b128 v[32:35], v16 offset:7904
  ds_read_b32 v144, v143 offset:4
  v_exp_f32 v114, v114
  v_exp_f32 v115, v115
  v_exp_f32 v116, v116
  v_exp_f32 v117, v117
  v_exp_f32 v118, v118
  v_exp_f32 v119, v119
  v_exp_f32 v120, v120
  v_exp_f32 v121, v121
  v_smfmac_f32_32x32x32_bf16 v[44:59], v[36:39], v[108:115], v14
  ds_read_b32 v26, v17 offset:5888
  v_exp_f32 v122, v122
  v_exp_f32 v123, v123
  v_exp_f32 v124, v124
  v_exp_f32 v125, v125
  v_smfmac_f32_32x32x32_bf16 v[44:59], v[40:43], v[116:123], v14
  ds_read2st64_b64 v[152:155], v151 offset0:11 offset1:13
  v_exp_f32 v126, v126
  v_exp_f32 v127, v127
  v_exp_f32 v128, v128
  v_exp_f32 v129, v129
  v_mfma_f32_32x32x16_bf16 v[76:91], v[20:23], v[4:7], v[76:91]
  v_exp_f32 v130, v130
  v_exp_f32 v131, v131
  v_exp_f32 v132, v132
  v_exp_f32 v133, v133
  v_smfmac_f32_32x32x32_bf16 v[60:75], v[36:39], v[124:131], v14
  v_exp_f32 v134, v134
  v_exp_f32 v135, v135
  v_exp_f32 v136, v136
  v_exp_f32 v137, v137
  v_mfma_f32_32x32x16_bf16 v[92:107], v[20:23], v[8:11], v[92:107]
  v_exp_f32 v138, v138
  v_exp_f32 v139, v139
  v_exp_f32 v76, v76
  v_exp_f32 v77, v77
  v_smfmac_f32_32x32x32_bf16 v[60:75], v[40:43], v[132:139], v14
  ds_read_b128 v[36:39], v16 offset:8512
  s_waitcnt lgkmcnt(1)
  v_exp_f32 v78, v78
  v_exp_f32 v79, v79
  v_exp_f32 v80, v80
  v_exp_f32 v81, v81
  v_mfma_f32_32x32x4_2b_bf16 v[108:139], v[26:27], v[12:13], 0
  ds_read_b128 v[40:43], v16 offset:9120
  v_readfirstlane_b32 s30, v144
  v_add_u32 v15, s45, v15
  v_add_u32 v17, s45, v17
  v_add_u32 v151, s45, v151
  v_add_u32 v143, 4, v143
  s_cmp_lt_u32 s30, 4
  s_cbranch_scc1 L_wait
L_waitret:
  v_exp_f32 v82, v82
  v_exp_f32 v83, v83
  v_exp_f32 v84, v84
  v_exp_f32 v85, v85
  v_exp_f32 v86, v86
  v_exp_f32 v87, v87
  v_exp_f32 v88, v88
  v_exp_f32 v89, v89
  v_smfmac_f32_32x32x32_bf16 v[44:59], v[28:31], v[76:83], v14
  ds_read_b32 v24, v17 offset:0
  v_exp_f32 v90, v90
  v_exp_f32 v91, v91
  v_exp_f32 v92, v92
  v_exp_f32 v93, v93
  v_smfmac_f32_32x32x32_bf16 v[44:59], v[32:35], v[84:91], v14
  ds_read2st64_b64 v[20:23], v15 offset0:0 offset1:2
  v_exp_f32 v94, v94
  v_exp_f32 v95, v95
  v_exp_f32 v96, v96
  v_exp_f32 v97, v97
  v_mfma_f32_32x32x16_bf16 v[108:123], v[152:155], v[4:7], v[108:123]
  v_exp_f32 v98, v98
  v_exp_f32 v99, v99
  v_exp_f32 v100, v100
  v_exp_f32 v101, v101
  v_smfmac_f32_32x32x32_bf16 v[60:75], v[28:31], v[92:99], v14
  v_exp_f32 v102, v102
  v_exp_f32 v103, v103
  v_exp_f32 v104, v104
  v_exp_f32 v105, v105
  v_mfma_f32_32x32x16_bf16 v[124:139], v[152:155], v[8:11], v[124:139]
  v_exp_f32 v106, v106
  v_exp_f32 v107, v107
  v_exp_f32 v108, v108
  v_exp_f32 v109, v109
  v_smfmac_f32_32x32x32_bf16 v[60:75], v[32:35], v[100:107], v14
  v_add_u32 v16, s45, v16
  ds_read_b128 v[28:31], v16 offset:0
  s_waitcnt lgkmcnt(1)
  v_exp_f32 v110, v110
  v_exp_f32 v111, v111
  v_exp_f32 v112, v112
  v_exp_f32 v113, v113
  v_mfma_f32_32x32x4_2b_bf16 v[76:107], v[24:25], v[12:13], 0
  ds_read_b128 v[32:35], v16 offset:608
  v_exp_f32 v114, v114
  v_exp_f32 v115, v115
  v_exp_f32 v116, v116
  v_exp_f32 v117, v117
  v_exp_f32 v118, v118
  v_exp_f32 v119, v119
  v_exp_f32 v120, v120
  v_exp_f32 v121, v121
  v_smfmac_f32_32x32x32_bf16 v[44:59], v[36:39], v[108:115], v14
  ds_read_b32 v26, v17 offset:256
  v_exp_f32 v122, v122
  v_exp_f32 v123, v123
  v_exp_f32 v124, v124
  v_exp_f32 v125, v125
  v_smfmac_f32_32x32x32_bf16 v[44:59], v[40:43], v[116:123], v14
  ds_read2st64_b64 v[152:155], v151 offset0:0 offset1:2
  v_exp_f32 v126, v126
  v_exp_f32 v127, v127
  v_exp_f32 v128, v128
  v_exp_f32 v129, v129
  v_mfma_f32_32x32x16_bf16 v[76:91], v[20:23], v[4:7], v[76:91]
  v_exp_f32 v130, v130
  v_exp_f32 v131, v131
  v_exp_f32 v132, v132
  v_exp_f32 v133, v133
  v_smfmac_f32_32x32x32_bf16 v[60:75], v[36:39], v[124:131], v14
  s_add_u32 s44, s44, 1
  s_cmp_lt_u32 s44, 8
  v_exp_f32 v134, v134
  v_exp_f32 v135, v135
  v_exp_f32 v136, v136
  v_exp_f32 v137, v137
  v_mfma_f32_32x32x16_bf16 v[92:107], v[20:23], v[8:11], v[92:107]
  v_exp_f32 v138, v138
  v_exp_f32 v139, v139
  s_cbranch_scc1 L_loop
  s_waitcnt lgkmcnt(0)
  s_nop 0
  v_smfmac_f32_32x32x32_bf16 v[60:75], v[40:43], v[132:139], v14
  s_mul_i32 s30, s29, 37888
  s_add_u32 s30, s30, 8388608
  s_lshl_b32 s31, s39, 10
  s_add_u32 s31, s31, s30
  s_lshl_b32 s32, s39, 7
  s_add_u32 s32, s32, s30
  s_add_u32 s32, s32, 32768
  v_lshlrev_b32 v18, 2, v2
  s_mov_b32 s30, 0x5d800000
  v_cndmask_b32 v54, v54, v56, s[62:63]
  v_rcp_f32 v55, v54
  v_cmp_nge_f32 s[16:17], s30, v54
  v_pk_mul_f32 v[44:45], v[44:45], v[54:55] op_sel:[0,1] op_sel_hi:[1,1]
  v_pk_mul_f32 v[46:47], v[46:47], v[54:55] op_sel:[0,1] op_sel_hi:[1,1]
  v_pk_mul_f32 v[48:49], v[48:49], v[54:55] op_sel:[0,1] op_sel_hi:[1,1]
  v_pk_mul_f32 v[50:51], v[50:51], v[54:55] op_sel:[0,1] op_sel_hi:[1,1]
  v_pk_mul_f32 v[52:53], v[52:53], v[54:55] op_sel:[0,1] op_sel_hi:[1,1]
  v_cvt_pk_bf16_f32 v108, v44, v45
  v_cvt_pk_bf16_f32 v109, v46, v47
  v_cvt_pk_bf16_f32 v110, v48, v49
  v_cvt_pk_bf16_f32 v111, v50, v51
  v_cvt_pk_bf16_f32 v112, v52, v53
  buffer_store_dwordx4 v[108:111], v3, s[4:7], s31 offen sc0 sc1
  s_mov_b32 exec_hi, 0
  buffer_store_dword v112, v18, s[4:7], s32 offen sc0 sc1
  s_mov_b32 exec_hi, -1
  s_add_u32 s31, s31, 37888
  s_add_u32 s32, s32, 37888
  v_cndmask_b32 v70, v70, v72, s[62:63]
  v_rcp_f32 v71, v70
  v_cmp_nge_f32 s[18:19], s30, v70
  v_pk_mul_f32 v[60:61], v[60:61], v[70:71] op_sel:[0,1] op_sel_hi:[1,1]
  v_pk_mul_f32 v[62:63], v[62:63], v[70:71] op_sel:[0,1] op_sel_hi:[1,1]
  v_pk_mul_f32 v[64:65], v[64:65], v[70:71] op_sel:[0,1] op_sel_hi:[1,1]
  v_pk_mul_f32 v[66:67], v[66:67], v[70:71] op_sel:[0,1] op_sel_hi:[1,1]
  v_pk_mul_f32 v[68:69], v[68:69], v[70:71] op_sel:[0,1] op_sel_hi:[1,1]
  v_cvt_pk_bf16_f32 v116, v60, v61
  v_cvt_pk_bf16_f32 v117, v62, v63
  v_cvt_pk_bf16_f32 v118, v64, v65
  v_cvt_pk_bf16_f32 v119, v66, v67
  v_cvt_pk_bf16_f32 v120, v68, v69
  buffer_store_dwordx4 v[116:119], v3, s[4:7], s31 offen sc0 sc1
  s_mov_b32 exec_hi, 0
  buffer_store_dword v120, v18, s[4:7], s32 offen sc0 sc1
  s_mov_b32 exec_hi, -1
  s_add_u32 s31, s31, 37888
  s_add_u32 s32, s32, 37888
  v_add_f32 v19, |v44|, |v60|
  v_add_f32 v16, |v45|, |v61|
  v_add_f32 v19, v19, v16
  v_add_f32 v16, |v46|, |v62|
  v_add_f32 v19, v19, v16
  v_add_f32 v16, |v47|, |v63|
  v_add_f32 v19, v19, v16
  v_add_f32 v16, |v48|, |v64|
  v_add_f32 v19, v19, v16
  v_add_f32 v16, |v49|, |v65|
  v_add_f32 v19, v19, v16
  v_add_f32 v16, |v50|, |v66|
  v_add_f32 v19, v19, v16
  v_add_f32 v16, |v51|, |v67|
  v_add_f32 v19, v19, v16
  v_add_f32 v16, |v52|, |v68|
  v_add_f32 v19, v19, v16
  v_add_f32 v16, |v53|, |v69|
  v_add_f32 v19, v19, v16
  s_mov_b32 s31, 0x7f7fffff
  s_or_b64 s[16:17], s[16:17], s[18:19]
  v_cmp_nge_f32 vcc, s31, v19
  s_or_b64 vcc, vcc, s[16:17]
  s_cmp_lg_u32 s47, 0
  s_cbranch_scc1 L_fin
  s_cmp_lg_u64 vcc, 0
  s_cbranch_scc1 L_unsafe
L_fin:
  v_mov_b32 v19, 1073741824
  s_lshl_b32 s36, s29, 5
  s_add_u32 s36, s36, s39
  s_lshl_b32 s36, s36, 2
  s_add_u32 s36, s36, 17835008
  s_add_u32 s35, s36, 128
  s_waitcnt vmcnt(0)
  v_mov_b32 v15, 0
  v_mov_b32 v16, 1
  s_mov_b64 exec, 1
  buffer_store_dword v16, v15, s[4:7], s36 offen sc0 sc1
  buffer_store_dword v16, v15, s[4:7], s35 offen sc0 sc1
  s_mov_b64 exec, -1
  ds_write_b32 v145, v19
  s_cmp_lg_u32 s47, 0
  s_cbranch_scc1 L_redo_end
  v_and_b32 v15, 3, v2
  v_lshlrev_b32 v15, 2, v15
  v_add_u32 v15, 159808, v15
  s_mov_b32 s33, 0
  s_mov_b32 s30, 1342177280
L_pg_35:
  ds_read_b32 v16, v15
  s_add_u32 s33, s33, 1
  s_waitcnt lgkmcnt(0)
  v_cmp_gt_u32 vcc, 1073741824, v16
  s_cmp_gt_u32 s33, 160000
  s_cbranch_scc1 L_pg_35x
  s_cbranch_vccz L_pg_35x
  s_sleep 4
  s_branch L_pg_35
L_pg_35x:
  v_cmp_eq_u32 vcc, s30, v16
  s_cbranch_vccnz L_redo
  s_branch L_exit
L_sig1:
  s_waitcnt vmcnt(0)
  s_mov_b64 exec, 1
  ds_add_u32 v143, v19 offset:4
  s_mov_b64 exec, -1
  s_waitcnt lgkmcnt(0)
  s_branch L_sig1r
L_wait:
  s_mov_b32 s33, 0
L_sp_36:
  ds_read_b32 v144, v143 offset:0
  s_add_u32 s33, s33, 1
  s_waitcnt lgkmcnt(0)
  v_readfirstlane_b32 s32, v144
  s_cmp_ge_u32 s32, 4
  s_cbranch_scc1 L_sp_36x
  s_cmp_lt_u32 s33, 320000
  s_cbranch_scc1 L_sp_36
L_sp_36x:
  s_branch L_waitret
L_unsafe:
  s_mov_b32 s47, 100
  v_mov_b32 v19, 1342177280
  ds_write_b32 v145, v19
L_redo:
  s_waitcnt vmcnt(0) lgkmcnt(0)
  s_barrier
  s_barrier
  s_cmp_eq_u32 s47, 0
  s_cbranch_scc1 L_redo_end
  s_mov_b32 s48, 64
  s_mov_b32 s49, 0
  v_mov_b32 v145, 159872
  s_branch L_maxpass
L_redo_end:
  s_waitcnt lgkmcnt(0)
  s_barrier
  s_branch L_exit
L_aux:
  s_setprio 3
  s_mov_b32 s27, 0
  s_mov_b32 s29, s26
  s_mov_b32 s62, 0
  s_mov_b32 s63, -1
  s_cmp_lg_u32 s3, 3
  s_cbranch_scc1 L_nopf
  s_getpc_b64 s[30:31]
L_pc:
  s_sub_u32 s30, s30, L_pc-L_code0
  s_subb_u32 s31, s31, 0
  s_lshl_b32 s32, s21, 10
  v_mov_b32 v6, v3
  s_cmp_ge_u32 s32, L_end-L_code0-1024
  s_cbranch_scc1 L_nopf
  s_add_u32 s30, s30, s32
  s_addc_u32 s31, s31, 0
  v_mov_b32 v5, s31
  v_add_co_u32 v4, vcc, s30, v6
  s_nop 1
  v_addc_co_u32 v5, vcc, 0, v5, vcc
  global_load_dword v154, v[4:5], off
L_nopf:
  s_waitcnt lgkmcnt(0)
  s_mov_b32 s4, s92
  s_and_b32 s5, s93, 0xffff
  s_mov_b32 s6, 268435456
  s_mov_b32 s7, 0x20000
  v_mov_b32 v8, 0
  v_mov_b32 v9, 0
  v_mov_b32 v10, 0
  v_mov_b32 v11, 0
  v_mov_b32 v152, 0
  s_cmp_lg_u32 s3, 2
  s_cbranch_scc1 L_notlb
  s_mov_b32 s30, 294912
  v_writelane_b32 v9, s30, 0
  s_mov_b32 s30, 1182720
  v_writelane_b32 v9, s30, 1
  s_mov_b32 s30, 2366464
  v_writelane_b32 v9, s30, 2
  s_mov_b32 s30, 3254272
  v_writelane_b32 v9, s30, 3
  s_mov_b32 s30, 4438016
  v_writelane_b32 v9, s30, 4
  s_mov_b32 s30, 5252096
  v_writelane_b32 v9, s30, 5
  s_mov_b32 s30, 6298624
  v_writelane_b32 v9, s30, 6
  s_mov_b32 s30, 7345152
  v_writelane_b32 v9, s30, 7
  s_mov_b32 s30, 8425472
  v_writelane_b32 v9, s30, 8
  s_mov_b32 s30, 9448448
  v_writelane_b32 v9, s30, 9
  s_mov_b32 s30, 10509312
  v_writelane_b32 v9, s30, 10
  s_mov_b32 s30, 11608064
  v_writelane_b32 v9, s30, 11
  s_mov_b32 s30, 12593152
  v_writelane_b32 v9, s30, 12
  s_mov_b32 s30, 13654016
  v_writelane_b32 v9, s30, 13
  s_mov_b32 s30, 14714880
  v_writelane_b32 v9, s30, 14
  s_mov_b32 s30, 15775744
  v_writelane_b32 v9, s30, 15
  s_mov_b32 s30, 17301504
  v_writelane_b32 v9, s30, 16
  s_mov_b32 s30, 18350080
  v_writelane_b32 v9, s30, 17
  s_mov_b64 exec, 262143
  buffer_load_dword v154, v9, s[4:7], 0 offen
  s_mov_b64 exec, 0x1ff
  v_lshlrev_b32 v9, 20, v2
  global_load_dword v154, v9, s[88:89]
  s_mov_b64 exec, 7
  global_load_dword v154, v9, s[70:71]
  s_mov_b64 exec, 1
  global_load_dword v154, v8, s[68:69]
  global_load_dword v154, v8, s[72:73]
  global_load_dword v154, v8, s[74:75]
  global_load_dword v154, v8, s[76:77]
  global_load_dword v154, v8, s[78:79]
  global_load_dword v154, v8, s[80:81]
  global_load_dword v154, v8, s[82:83]
  global_load_dword v154, v8, s[84:85]
  global_load_dword v154, v8, s[86:87]
  s_mov_b64 exec, -1
L_notlb:
  s_cmp_eq_u32 s24, 2
  s_cbranch_scc1 L_aux_sp
  s_lshl_b32 s30, s25, 6
  v_lshl_add_u32 v23, v1, 1, s30
  global_load_ushort v16, v23, s[72:73]
  global_load_ushort v17, v23, s[74:75]
  global_load_ushort v18, v23, s[84:85]
  s_waitcnt vmcnt(0)
  v_lshlrev_b32 v16, 16, v16
  v_lshlrev_b32 v17, 16, v17
  v_lshlrev_b32 v18, 16, v18
  v_mul_f32 v18, 0x3fb8aa3b, v18
  v_exp_f32 v18, v18
  s_nop 0
  v_cvt_pk_bf16_f32 v18, v18, v18
  v_lshlrev_b32 v18, 16, v18
  v_mul_f32 v19, v18, v16
  v_mul_f32 v20, v18, v17
  v_mul_f32 v19, 0x3fb8aa3b, v19
  v_mul_f32 v20, 0x3e22f983, v20
  v_exp_f32 v19, v19
  v_fract_f32 v20, v20
  v_cos_f32 v21, v20
  v_sin_f32 v22, v20
  s_nop 0
  v_mul_f32 v10, v19, v21
  v_mul_f32 v11, v19, v22
  v_mul_f32 v19, v16, v16
  v_fmac_f32 v19, v17, v17
  v_rcp_f32 v19, v19
  v_add_f32 v20, -1.0, v10
  v_mul_f32 v21, v20, v16
  v_fmac_f32 v21, v11, v17
  v_mul_f32 v22, v11, v16
  v_fma_f32 v22, -v20, v17, v22
  v_add_f32 v19, v19, v19
  v_mul_f32 v12, v21, v19
  v_mul_f32 v13, v22, v19
  v_mov_b32 v14, v10
  v_mov_b32 v15, v11
  v_mul_f32 v19, v15, v15
  v_mul_f32 v20, v14, v15
  v_fma_f32 v14, v14, v14, -v19
  v_add_f32 v15, v20, v20
  v_mul_f32 v19, v15, v15
  v_mul_f32 v20, v14, v15
  v_fma_f32 v14, v14, v14, -v19
  v_add_f32 v15, v20, v20
  v_mul_f32 v19, v15, v15
  v_mul_f32 v20, v14, v15
  v_fma_f32 v14, v14, v14, -v19
  v_add_f32 v15, v20, v20
  v_mul_f32 v19, v15, v15
  v_mul_f32 v20, v14, v15
  v_fma_f32 v14, v14, v14, -v19
  v_add_f32 v15, v20, v20
  s_mov_b32 s12, s70
  s_and_b32 s13, s71, 0xffff
  s_mov_b32 s14, 2359296
  s_mov_b32 s15, 0x20000
  s_and_b32 s30, s20, 3
  s_mul_i32 s30, s30, 589824
  s_lshr_b32 s31, s20, 2
  s_mul_i32 s31, s31, 28
  s_add_u32 s31, s31, s21
  s_lshl_b32 s31, s31, 2
  s_add_u32 s31, s31, s3
  s_mul_i32 s31, s31, 2688
  s_add_u32 s30, s30, s31
  v_lshlrev_b32 v16, 6, v2
  s_mov_b32 exec_hi, 0x3ff
  buffer_load_dword v154, v16, s[12:15], s30 offen
  s_mov_b32 exec_hi, -1
  s_cmp_lt_u32 s51, 2
  s_cselect_b32 s12, s76, s78
  s_cselect_b32 s13, s77, s79
  s_and_b32 s13, s13, 0xffff
  s_mov_b32 s14, 663552
  s_mov_b32 s15, 0x20000
  s_lshl_b32 s30, s21, 1
  s_and_b32 s31, s51, 1
  s_add_u32 s30, s30, s31
  s_mul_i32 s30, s30, 5952
  s_lshr_b32 s31, s20, 2
  s_mul_i32 s31, s31, 331776
  s_add_u32 s45, s30, s31
  s_add_u32 s46, s45, 4096
  v_lshlrev_b32 v155, 6, v2
  s_lshr_b32 s43, s3, 1
  s_and_b32 s44, s3, 1
  s_lshl_b32 s30, s43, 13
  v_lshrrev_b32 v149, 5, v2
  v_bfe_u32 v150, v1, 1, 3
  v_xor_b32 v150, v150, v149
  v_lshlrev_b32 v151, 7, v1
  v_add_u32 v151, s30, v151
  v_xor_b32 v152, 0, v150
  v_lshl_add_u32 v4, v152, 4, v151
  v_xor_b32 v152, 2, v150
  v_lshl_add_u32 v5, v152, 4, v151
  v_xor_b32 v152, 4, v150
  v_lshl_add_u32 v6, v152, 4, v151
  v_xor_b32 v152, 6, v150
  v_lshl_add_u32 v7, v152, 4, v151
  v_bfe_u32 v150, v2, 2, 2
  v_lshl_add_u32 v151, v149, 3, v150
  v_lshlrev_b32 v151, 8, v151
  v_bfe_u32 v152, v2, 4, 1
  v_lshl_add_u32 v151, v152, 5, v151
  v_and_b32 v152, 3, v2
  v_lshl_add_u32 v151, v152, 3, v151
  v_add_u32 v151, 16384, v151
  s_lshl_b32 s30, s44, 1
  v_xor_b32 v152, s30, v150
  v_lshl_add_u32 v8, v152, 6, v151
  v_xor_b32 v9, 64, v8
  v_mov_b32 v80, 0
  v_mov_b32 v81, 0
  v_mov_b32 v82, 0
  v_mov_b32 v83, 0
  v_mov_b32 v84, 0
  v_mov_b32 v85, 0
  v_mov_b32 v86, 0
  v_mov_b32 v87, 0
  v_mov_b32 v88, 0
  v_mov_b32 v89, 0
  v_mov_b32 v90, 0
  v_mov_b32 v91, 0
  v_mov_b32 v92, 0
  v_mov_b32 v93, 0
  v_mov_b32 v94, 0
  v_mov_b32 v95, 0
  v_mov_b32 v96, 0
  v_mov_b32 v97, 0
  v_mov_b32 v98, 0
  v_mov_b32 v99, 0
  v_mov_b32 v100, 0
  v_mov_b32 v101, 0
  v_mov_b32 v102, 0
  v_mov_b32 v103, 0
  v_mov_b32 v104, 0
  v_mov_b32 v105, 0
  v_mov_b32 v106, 0
  v_mov_b32 v107, 0
  v_mov_b32 v108, 0
  v_mov_b32 v109, 0
  v_mov_b32 v110, 0
  v_mov_b32 v111, 0
  v_mov_b32 v112, 0
  v_mov_b32 v113, 0
  v_mov_b32 v114, 0
  v_mov_b32 v115, 0
  v_mov_b32 v116, 0
  v_mov_b32 v117, 0
  v_mov_b32 v118, 0
  v_mov_b32 v119, 0
  v_mov_b32 v120, 0
  v_mov_b32 v121, 0
  v_mov_b32 v122, 0
  v_mov_b32 v123, 0
  v_mov_b32 v124, 0
  v_mov_b32 v125, 0
  v_mov_b32 v126, 0
  v_mov_b32 v127, 0
  v_mov_b32 v128, 0
  v_mov_b32 v129, 0
  v_mov_b32 v130, 0
  v_mov_b32 v131, 0
  v_mov_b32 v132, 0
  v_mov_b32 v133, 0
  v_mov_b32 v134, 0
  v_mov_b32 v135, 0
  v_mov_b32 v136, 0
  v_mov_b32 v137, 0
  v_mov_b32 v138, 0
  v_mov_b32 v139, 0
  v_mov_b32 v140, 0
  v_mov_b32 v141, 0
  v_mov_b32 v142, 0
  v_mov_b32 v143, 0
  s_mov_b32 s40, 0
  s_mov_b32 s41, 0
  s_barrier
  ds_read_b128 v[16:19], v4 offset:0
  ds_read_b128 v[20:23], v4 offset:4096
  ds_read_b64_tr_b16 v[24:25], v8 offset:0
  ds_read_b64_tr_b16 v[26:27], v8 offset:1024
  ds_read_b64_tr_b16 v[28:29], v9 offset:0
  ds_read_b64_tr_b16 v[30:31], v9 offset:1024
  ds_read_b128 v[32:35], v5 offset:0
  ds_read_b128 v[36:39], v5 offset:4096
  ds_read_b64_tr_b16 v[40:41], v8 offset:4096
  ds_read_b64_tr_b16 v[42:43], v8 offset:5120
  ds_read_b64_tr_b16 v[44:45], v9 offset:4096
  ds_read_b64_tr_b16 v[46:47], v9 offset:5120
  s_cmp_eq_u32 s24, 1
  s_cbranch_scc1 L_a1v
L_a1qk:
  s_waitcnt lgkmcnt(6)
  v_mfma_f32_32x32x16_bf16 v[80:95], v[24:27], v[16:19], v[80:95]
  ds_read_b128 v[48:51], v6 offset:0
  ds_read_b128 v[52:55], v6 offset:4096
  v_mfma_f32_32x32x16_bf16 v[96:111], v[28:31], v[16:19], v[96:111]
  ds_read_b64_tr_b16 v[56:57], v8 offset:8192
  ds_read_b64_tr_b16 v[58:59], v8 offset:9216
  v_mfma_f32_32x32x16_bf16 v[112:127], v[24:27], v[20:23], v[112:127]
  ds_read_b64_tr_b16 v[60:61], v9 offset:8192
  ds_read_b64_tr_b16 v[62:63], v9 offset:9216
  v_mfma_f32_32x32x16_bf16 v[128:143], v[28:31], v[20:23], v[128:143]
  s_add_u32 s30, s41, 32768
  s_cmp_eq_u32 s30, 163840
  s_cselect_b32 s30, 0, s30
  s_sub_u32 s42, s30, s41
  s_mov_b32 s41, s30
  s_add_u32 s40, s40, 1
  s_waitcnt lgkmcnt(6)
  v_mfma_f32_32x32x16_bf16 v[80:95], v[40:43], v[32:35], v[80:95]
  ds_read_b128 v[64:67], v7 offset:0
  ds_read_b128 v[68:71], v7 offset:4096
  v_mfma_f32_32x32x16_bf16 v[96:111], v[44:47], v[32:35], v[96:111]
  ds_read_b64_tr_b16 v[72:73], v8 offset:12288
  ds_read_b64_tr_b16 v[74:75], v8 offset:13312
  v_mfma_f32_32x32x16_bf16 v[112:127], v[40:43], v[36:39], v[112:127]
  ds_read_b64_tr_b16 v[76:77], v9 offset:12288
  ds_read_b64_tr_b16 v[78:79], v9 offset:13312
  v_mfma_f32_32x32x16_bf16 v[128:143], v[44:47], v[36:39], v[128:143]
  v_add_u32 v4, s42, v4
  v_add_u32 v5, s42, v5
  v_add_u32 v6, s42, v6
  v_add_u32 v7, s42, v7
  v_add_u32 v8, s42, v8
  v_add_u32 v9, s42, v9
  s_waitcnt lgkmcnt(6)
  s_cmp_lt_u32 s40, 9
  s_cbranch_scc1 L_a1qkb
  s_waitcnt lgkmcnt(0)
L_a1qkb:
  s_barrier
  v_mfma_f32_32x32x16_bf16 v[80:95], v[56:59], v[48:51], v[80:95]
  ds_read_b128 v[16:19], v4 offset:0
  ds_read_b128 v[20:23], v4 offset:4096
  v_mfma_f32_32x32x16_bf16 v[96:111], v[60:63], v[48:51], v[96:111]
  ds_read_b64_tr_b16 v[24:25], v8 offset:0
  ds_read_b64_tr_b16 v[26:27], v8 offset:1024
  v_mfma_f32_32x32x16_bf16 v[112:127], v[56:59], v[52:55], v[112:127]
  ds_read_b64_tr_b16 v[28:29], v9 offset:0
  ds_read_b64_tr_b16 v[30:31], v9 offset:1024
  v_mfma_f32_32x32x16_bf16 v[128:143], v[60:63], v[52:55], v[128:143]
  s_waitcnt lgkmcnt(6)
  v_mfma_f32_32x32x16_bf16 v[80:95], v[72:75], v[64:67], v[80:95]
  ds_read_b128 v[32:35], v5 offset:0
  ds_read_b128 v[36:39], v5 offset:4096
  v_mfma_f32_32x32x16_bf16 v[96:111], v[76:79], v[64:67], v[96:111]
  ds_read_b64_tr_b16 v[40:41], v8 offset:4096
  ds_read_b64_tr_b16 v[42:43], v8 offset:5120
  v_mfma_f32_32x32x16_bf16 v[112:127], v[72:75], v[68:71], v[112:127]
  ds_read_b64_tr_b16 v[44:45], v9 offset:4096
  ds_read_b64_tr_b16 v[46:47], v9 offset:5120
  v_mfma_f32_32x32x16_bf16 v[128:143], v[76:79], v[68:71], v[128:143]
  s_cmp_lt_u32 s40, 9
  s_cbranch_scc1 L_a1qk
  v_mov_b32 v152, 0
  global_load_dword v153, v152, s[90:91]
  s_lshl_b32 s30, s23, 5
  s_lshl_b32 s31, s44, 4
  s_add_u32 s30, s30, s31
  s_mul_i32 s31, s22, 289
  s_add_u32 s31, s31, s30
  s_lshl_b32 s31, s31, 10
  s_lshl_b32 s32, s43, 9
  s_add_u32 s31, s31, s32
  s_add_u32 s31, s31, 0
  v_lshlrev_b32 v150, 4, v1
  v_lshl_add_u32 v150, v149, 10, v150
  s_mov_b32 s32, 0x3eae1a93
  s_cmp_ge_u32 s30, 144
  s_cselect_b32 s32, 1.0, s32
  s_mov_b32 s33, s32
  s_waitcnt lgkmcnt(0)
  v_pk_mul_f32 v[80:81], v[80:81], s[32:33]
  v_pk_mul_f32 v[82:83], v[82:83], s[32:33]
  v_pk_mul_f32 v[112:113], v[112:113], s[32:33]
  v_pk_mul_f32 v[114:115], v[114:115], s[32:33]
  v_cvt_pk_bf16_f32 v16, v80, v81
  v_cvt_pk_bf16_f32 v17, v82, v83
  v_cvt_pk_bf16_f32 v18, v112, v113
  v_cvt_pk_bf16_f32 v19, v114, v115
  buffer_store_dwordx4 v[16:19], v150, s[4:7], s31 offen offset:0 sc0 sc1
  v_pk_mul_f32 v[84:85], v[84:85], s[32:33]
  v_pk_mul_f32 v[86:87], v[86:87], s[32:33]
  v_pk_mul_f32 v[116:117], v[116:117], s[32:33]
  v_pk_mul_f32 v[118:119], v[118:119], s[32:33]
  v_cvt_pk_bf16_f32 v20, v84, v85
  v_cvt_pk_bf16_f32 v21, v86, v87
  v_cvt_pk_bf16_f32 v22, v116, v117
  v_cvt_pk_bf16_f32 v23, v118, v119
  buffer_store_dwordx4 v[20:23], v150, s[4:7], s31 offen offset:2048 sc0 sc1
  s_add_u32 s31, s31, 4096
  v_pk_mul_f32 v[88:89], v[88:89], s[32:33]
  v_pk_mul_f32 v[90:91], v[90:91], s[32:33]
  v_pk_mul_f32 v[120:121], v[120:121], s[32:33]
  v_pk_mul_f32 v[122:123], v[122:123], s[32:33]
  v_cvt_pk_bf16_f32 v24, v88, v89
  v_cvt_pk_bf16_f32 v25, v90, v91
  v_cvt_pk_bf16_f32 v26, v120, v121
  v_cvt_pk_bf16_f32 v27, v122, v123
  buffer_store_dwordx4 v[24:27], v150, s[4:7], s31 offen offset:0 sc0 sc1
  v_pk_mul_f32 v[92:93], v[92:93], s[32:33]
  v_pk_mul_f32 v[94:95], v[94:95], s[32:33]
  v_pk_mul_f32 v[124:125], v[124:125], s[32:33]
  v_pk_mul_f32 v[126:127], v[126:127], s[32:33]
  v_cvt_pk_bf16_f32 v28, v92, v93
  v_cvt_pk_bf16_f32 v29, v94, v95
  v_cvt_pk_bf16_f32 v30, v124, v125
  v_cvt_pk_bf16_f32 v31, v126, v127
  buffer_store_dwordx4 v[28:31], v150, s[4:7], s31 offen offset:2048 sc0 sc1
  s_add_u32 s31, s31, 4096
  v_pk_mul_f32 v[96:97], v[96:97], s[32:33]
  v_pk_mul_f32 v[98:99], v[98:99], s[32:33]
  v_pk_mul_f32 v[128:129], v[128:129], s[32:33]
  v_pk_mul_f32 v[130:131], v[130:131], s[32:33]
  v_cvt_pk_bf16_f32 v32, v96, v97
  v_cvt_pk_bf16_f32 v33, v98, v99
  v_cvt_pk_bf16_f32 v34, v128, v129
  v_cvt_pk_bf16_f32 v35, v130, v131
  buffer_store_dwordx4 v[32:35], v150, s[4:7], s31 offen offset:0 sc0 sc1
  v_pk_mul_f32 v[100:101], v[100:101], s[32:33]
  v_pk_mul_f32 v[102:103], v[102:103], s[32:33]
  v_pk_mul_f32 v[132:133], v[132:133], s[32:33]
  v_pk_mul_f32 v[134:135], v[134:135], s[32:33]
  v_cvt_pk_bf16_f32 v36, v100, v101
  v_cvt_pk_bf16_f32 v37, v102, v103
  v_cvt_pk_bf16_f32 v38, v132, v133
  v_cvt_pk_bf16_f32 v39, v134, v135
  buffer_store_dwordx4 v[36:39], v150, s[4:7], s31 offen offset:2048 sc0 sc1
  s_add_u32 s31, s31, 4096
  v_pk_mul_f32 v[104:105], v[104:105], s[32:33]
  v_pk_mul_f32 v[106:107], v[106:107], s[32:33]
  v_pk_mul_f32 v[136:137], v[136:137], s[32:33]
  v_pk_mul_f32 v[138:139], v[138:139], s[32:33]
  v_cvt_pk_bf16_f32 v40, v104, v105
  v_cvt_pk_bf16_f32 v41, v106, v107
  v_cvt_pk_bf16_f32 v42, v136, v137
  v_cvt_pk_bf16_f32 v43, v138, v139
  buffer_store_dwordx4 v[40:43], v150, s[4:7], s31 offen offset:0 sc0 sc1
  v_pk_mul_f32 v[108:109], v[108:109], s[32:33]
  v_pk_mul_f32 v[110:111], v[110:111], s[32:33]
  v_pk_mul_f32 v[140:141], v[140:141], s[32:33]
  v_pk_mul_f32 v[142:143], v[142:143], s[32:33]
  v_cvt_pk_bf16_f32 v44, v108, v109
  v_cvt_pk_bf16_f32 v45, v110, v111
  v_cvt_pk_bf16_f32 v46, v140, v141
  v_cvt_pk_bf16_f32 v47, v142, v143
  buffer_store_dwordx4 v[44:47], v150, s[4:7], s31 offen offset:2048 sc0 sc1
  s_add_u32 s31, s31, 4096
  s_branch L_a1done
L_a1v:
  s_waitcnt lgkmcnt(6)
  v_mfma_f32_32x32x16_bf16 v[80:95], v[16:19], v[24:27], v[80:95]
  ds_read_b128 v[48:51], v6 offset:0
  ds_read_b128 v[52:55], v6 offset:4096
  v_mfma_f32_32x32x16_bf16 v[96:111], v[16:19], v[28:31], v[96:111]
  ds_read_b64_tr_b16 v[56:57], v8 offset:8192
  ds_read_b64_tr_b16 v[58:59], v8 offset:9216
  v_mfma_f32_32x32x16_bf16 v[112:127], v[20:23], v[24:27], v[112:127]
  ds_read_b64_tr_b16 v[60:61], v9 offset:8192
  ds_read_b64_tr_b16 v[62:63], v9 offset:9216
  v_mfma_f32_32x32x16_bf16 v[128:143], v[20:23], v[28:31], v[128:143]
  s_add_u32 s30, s41, 32768
  s_cmp_eq_u32 s30, 163840
  s_cselect_b32 s30, 0, s30
  s_sub_u32 s42, s30, s41
  s_mov_b32 s41, s30
  s_add_u32 s40, s40, 1
  s_waitcnt lgkmcnt(6)
  v_mfma_f32_32x32x16_bf16 v[80:95], v[32:35], v[40:43], v[80:95]
  ds_read_b128 v[64:67], v7 offset:0
  ds_read_b128 v[68:71], v7 offset:4096
  v_mfma_f32_32x32x16_bf16 v[96:111], v[32:35], v[44:47], v[96:111]
  ds_read_b64_tr_b16 v[72:73], v8 offset:12288
  ds_read_b64_tr_b16 v[74:75], v8 offset:13312
  v_mfma_f32_32x32x16_bf16 v[112:127], v[36:39], v[40:43], v[112:127]
  ds_read_b64_tr_b16 v[76:77], v9 offset:12288
  ds_read_b64_tr_b16 v[78:79], v9 offset:13312
  v_mfma_f32_32x32x16_bf16 v[128:143], v[36:39], v[44:47], v[128:143]
  v_add_u32 v4, s42, v4
  v_add_u32 v5, s42, v5
  v_add_u32 v6, s42, v6
  v_add_u32 v7, s42, v7
  v_add_u32 v8, s42, v8
  v_add_u32 v9, s42, v9
  s_waitcnt lgkmcnt(6)
  s_cmp_lt_u32 s40, 9
  s_cbranch_scc1 L_a1vb
  s_waitcnt lgkmcnt(0)
L_a1vb:
  s_barrier
  v_mfma_f32_32x32x16_bf16 v[80:95], v[48:51], v[56:59], v[80:95]
  ds_read_b128 v[16:19], v4 offset:0
  ds_read_b128 v[20:23], v4 offset:4096
  v_mfma_f32_32x32x16_bf16 v[96:111], v[48:51], v[60:63], v[96:111]
  ds_read_b64_tr_b16 v[24:25], v8 offset:0
  ds_read_b64_tr_b16 v[26:27], v8 offset:1024
  v_mfma_f32_32x32x16_bf16 v[112:127], v[52:55], v[56:59], v[112:127]
  ds_read_b64_tr_b16 v[28:29], v9 offset:0
  ds_read_b64_tr_b16 v[30:31], v9 offset:1024
  v_mfma_f32_32x32x16_bf16 v[128:143], v[52:55], v[60:63], v[128:143]
  s_waitcnt lgkmcnt(6)
  v_mfma_f32_32x32x16_bf16 v[80:95], v[64:67], v[72:75], v[80:95]
  ds_read_b128 v[32:35], v5 offset:0
  ds_read_b128 v[36:39], v5 offset:4096
  v_mfma_f32_32x32x16_bf16 v[96:111], v[64:67], v[76:79], v[96:111]
  ds_read_b64_tr_b16 v[40:41], v8 offset:4096
  ds_read_b64_tr_b16 v[42:43], v8 offset:5120
  v_mfma_f32_32x32x16_bf16 v[112:127], v[68:71], v[72:75], v[112:127]
  ds_read_b64_tr_b16 v[44:45], v9 offset:4096
  ds_read_b64_tr_b16 v[46:47], v9 offset:5120
  v_mfma_f32_32x32x16_bf16 v[128:143], v[68:71], v[76:79], v[128:143]
  s_cmp_lt_u32 s40, 9
  s_cbranch_scc1 L_a1v
  v_mov_b32 v152, 0
  global_load_dword v153, v152, s[90:91]
  s_sub_u32 s30, s23, 9
  s_lshl_b32 s30, s30, 7
  s_lshl_b32 s31, s44, 6
  s_add_u32 s30, s30, s31
  s_lshl_b32 s31, s22, 4
  s_lshl_b32 s32, s43, 3
  s_add_u32 s31, s31, s32
  s_mul_i32 s31, s31, 9344
  s_lshl_b32 s32, s30, 4
  s_add_u32 s31, s31, s32
  s_add_u32 s31, s31, 5242880
  v_mul_u32_u24 v150, 9344, v149
  v_lshl_add_u32 v150, v1, 4, v150
  s_waitcnt lgkmcnt(0)
  s_cmp_ge_u32 s30, 576
  s_cbranch_scc1 L_a1done
  v_cvt_pk_bf16_f32 v80, v80, v81
  v_cvt_pk_bf16_f32 v81, v82, v83
  v_cvt_pk_bf16_f32 v82, v84, v85
  v_cvt_pk_bf16_f32 v83, v86, v87
  buffer_store_dwordx4 v[80:83], v150, s[4:7], s31 offen offset:0 sc0 sc1
  v_cvt_pk_bf16_f32 v96, v96, v97
  v_cvt_pk_bf16_f32 v97, v98, v99
  v_cvt_pk_bf16_f32 v98, v100, v101
  v_cvt_pk_bf16_f32 v99, v102, v103
  buffer_store_dwordx4 v[96:99], v150, s[4:7], s31 offen offset:512 sc0 sc1
  s_add_u32 s31, s31, 18688
  v_cvt_pk_bf16_f32 v88, v88, v89
  v_cvt_pk_bf16_f32 v89, v90, v91
  v_cvt_pk_bf16_f32 v90, v92, v93
  v_cvt_pk_bf16_f32 v91, v94, v95
  buffer_store_dwordx4 v[88:91], v150, s[4:7], s31 offen offset:0 sc0 sc1
  v_cvt_pk_bf16_f32 v104, v104, v105
  v_cvt_pk_bf16_f32 v105, v106, v107
  v_cvt_pk_bf16_f32 v106, v108, v109
  v_cvt_pk_bf16_f32 v107, v110, v111
  buffer_store_dwordx4 v[104:107], v150, s[4:7], s31 offen offset:512 sc0 sc1
  s_add_u32 s31, s31, 18688
  v_cvt_pk_bf16_f32 v112, v112, v113
  v_cvt_pk_bf16_f32 v113, v114, v115
  v_cvt_pk_bf16_f32 v114, v116, v117
  v_cvt_pk_bf16_f32 v115, v118, v119
  buffer_store_dwordx4 v[112:115], v150, s[4:7], s31 offen offset:0 sc0 sc1
  v_cvt_pk_bf16_f32 v128, v128, v129
  v_cvt_pk_bf16_f32 v129, v130, v131
  v_cvt_pk_bf16_f32 v130, v132, v133
  v_cvt_pk_bf16_f32 v131, v134, v135
  buffer_store_dwordx4 v[128:131], v150, s[4:7], s31 offen offset:512 sc0 sc1
  s_add_u32 s31, s31, 18688
  v_cvt_pk_bf16_f32 v120, v120, v121
  v_cvt_pk_bf16_f32 v121, v122, v123
  v_cvt_pk_bf16_f32 v122, v124, v125
  v_cvt_pk_bf16_f32 v123, v126, v127
  buffer_store_dwordx4 v[120:123], v150, s[4:7], s31 offen offset:0 sc0 sc1
  v_cvt_pk_bf16_f32 v136, v136, v137
  v_cvt_pk_bf16_f32 v137, v138, v139
  v_cvt_pk_bf16_f32 v138, v140, v141
  v_cvt_pk_bf16_f32 v139, v142, v143
  buffer_store_dwordx4 v[136:139], v150, s[4:7], s31 offen offset:512 sc0 sc1
  s_add_u32 s31, s31, 18688
L_a1done:
  s_mov_b32 s27, 1
  s_mov_b32 s29, s25
  s_branch L_b1pre
L_aux_sp:
  s_barrier
  s_lshl_b32 s30, s2, 4
  s_add_u32 s30, s30, s3
  s_cmp_lg_u32 s30, 4080
  s_cbranch_scc1 L_nz
  s_mov_b32 s30, 17825792
  v_mov_b32 v24, 0
  v_mov_b32 v25, 0
  v_mov_b32 v26, 0
  v_mov_b32 v27, 0
  buffer_store_dwordx4 v[24:27], v3, s[4:7], s30 offen offset:0 sc0 sc1
  buffer_store_dwordx4 v[24:27], v3, s[4:7], s30 offen offset:1024 sc0 sc1
  buffer_store_dwordx4 v[24:27], v3, s[4:7], s30 offen offset:2048 sc0 sc1
  buffer_store_dwordx4 v[24:27], v3, s[4:7], s30 offen offset:3072 sc0 sc1
  s_add_u32 s30, s30, 4096
  buffer_store_dwordx4 v[24:27], v3, s[4:7], s30 offen offset:0 sc0 sc1
  buffer_store_dwordx4 v[24:27], v3, s[4:7], s30 offen offset:1024 sc0 sc1
  buffer_store_dwordx4 v[24:27], v3, s[4:7], s30 offen offset:2048 sc0 sc1
  buffer_store_dwordx4 v[24:27], v3, s[4:7], s30 offen offset:3072 sc0 sc1
  s_add_u32 s30, s30, 4096
  buffer_store_dwordx4 v[24:27], v3, s[4:7], s30 offen offset:0 sc0 sc1
  buffer_store_dwordx4 v[24:27], v3, s[4:7], s30 offen offset:1024 sc0 sc1
  buffer_store_dwordx4 v[24:27], v3, s[4:7], s30 offen offset:2048 sc0 sc1
  buffer_store_dwordx4 v[24:27], v3, s[4:7], s30 offen offset:3072 sc0 sc1
  s_add_u32 s30, s30, 4096
  buffer_store_dwordx4 v[24:27], v3, s[4:7], s30 offen offset:0 sc0 sc1
  buffer_store_dwordx4 v[24:27], v3, s[4:7], s30 offen offset:1024 sc0 sc1
  buffer_store_dwordx4 v[24:27], v3, s[4:7], s30 offen offset:2048 sc0 sc1
  buffer_store_dwordx4 v[24:27], v3, s[4:7], s30 offen offset:3072 sc0 sc1
  s_add_u32 s30, s30, 4096
  buffer_store_dwordx4 v[24:27], v3, s[4:7], s30 offen offset:0 sc0 sc1
  buffer_store_dwordx4 v[24:27], v3, s[4:7], s30 offen offset:1024 sc0 sc1
  buffer_store_dwordx4 v[24:27], v3, s[4:7], s30 offen offset:2048 sc0 sc1
  buffer_store_dwordx4 v[24:27], v3, s[4:7], s30 offen offset:3072 sc0 sc1
  s_add_u32 s30, s30, 4096
  buffer_store_dwordx4 v[24:27], v3, s[4:7], s30 offen offset:0 sc0 sc1
  buffer_store_dwordx4 v[24:27], v3, s[4:7], s30 offen offset:1024 sc0 sc1
  buffer_store_dwordx4 v[24:27], v3, s[4:7], s30 offen offset:2048 sc0 sc1
  buffer_store_dwordx4 v[24:27], v3, s[4:7], s30 offen offset:3072 sc0 sc1
  s_add_u32 s30, s30, 4096
  buffer_store_dwordx4 v[24:27], v3, s[4:7], s30 offen offset:0 sc0 sc1
  buffer_store_dwordx4 v[24:27], v3, s[4:7], s30 offen offset:1024 sc0 sc1
  buffer_store_dwordx4 v[24:27], v3, s[4:7], s30 offen offset:2048 sc0 sc1
  buffer_store_dwordx4 v[24:27], v3, s[4:7], s30 offen offset:3072 sc0 sc1
  s_add_u32 s30, s30, 4096
  buffer_store_dwordx4 v[24:27], v3, s[4:7], s30 offen offset:0 sc0 sc1
  buffer_store_dwordx4 v[24:27], v3, s[4:7], s30 offen offset:1024 sc0 sc1
  buffer_store_dwordx4 v[24:27], v3, s[4:7], s30 offen offset:2048 sc0 sc1
  buffer_store_dwordx4 v[24:27], v3, s[4:7], s30 offen offset:3072 sc0 sc1
  s_add_u32 s30, s30, 4096
  buffer_store_dwordx4 v[24:27], v3, s[4:7], s30 offen offset:0 sc0 sc1
  buffer_store_dwordx4 v[24:27], v3, s[4:7], s30 offen offset:1024 sc0 sc1
  buffer_store_dwordx4 v[24:27], v3, s[4:7], s30 offen offset:2048 sc0 sc1
  buffer_store_dwordx4 v[24:27], v3, s[4:7], s30 offen offset:3072 sc0 sc1
  s_add_u32 s30, s30, 4096
  buffer_store_dwordx4 v[24:27], v3, s[4:7], s30 offen offset:0 sc0 sc1
  buffer_store_dwordx4 v[24:27], v3, s[4:7], s30 offen offset:1024 sc0 sc1
  buffer_store_dwordx4 v[24:27], v3, s[4:7], s30 offen offset:2048 sc0 sc1
  buffer_store_dwordx4 v[24:27], v3, s[4:7], s30 offen offset:3072 sc0 sc1
  s_add_u32 s30, s30, 4096
  buffer_store_dwordx4 v[24:27], v3, s[4:7], s30 offen offset:0 sc0 sc1
  buffer_store_dwordx4 v[24:27], v3, s[4:7], s30 offen offset:1024 sc0 sc1
  buffer_store_dwordx4 v[24:27], v3, s[4:7], s30 offen offset:2048 sc0 sc1
  buffer_store_dwordx4 v[24:27], v3, s[4:7], s30 offen offset:3072 sc0 sc1
  s_add_u32 s30, s30, 4096
  buffer_store_dwordx4 v[24:27], v3, s[4:7], s30 offen offset:0 sc0 sc1
  buffer_store_dwordx4 v[24:27], v3, s[4:7], s30 offen offset:1024 sc0 sc1
  buffer_store_dwordx4 v[24:27], v3, s[4:7], s30 offen offset:2048 sc0 sc1
  buffer_store_dwordx4 v[24:27], v3, s[4:7], s30 offen offset:3072 sc0 sc1
  s_add_u32 s30, s30, 4096
  buffer_store_dwordx4 v[24:27], v3, s[4:7], s30 offen offset:0 sc0 sc1
  s_waitcnt vmcnt(0)
  v_mov_b32 v28, 1
  s_mov_b64 exec, 1
  global_store_dword v8, v28, s[90:91] sc0 sc1
  s_mov_b64 exec, -1
L_nz:
  s_lshl_b32 s30, s26, 6
  v_lshl_add_u32 v23, v1, 1, s30
  global_load_ushort v16, v23, s[72:73]
  global_load_ushort v17, v23, s[74:75]
  global_load_ushort v18, v23, s[84:85]
  s_waitcnt vmcnt(0)
  v_lshlrev_b32 v16, 16, v16
  v_lshlrev_b32 v17, 16, v17
  v_lshlrev_b32 v18, 16, v18
  v_mul_f32 v18, 0x3fb8aa3b, v18
  v_exp_f32 v18, v18
  s_nop 0
  v_cvt_pk_bf16_f32 v18, v18, v18
  v_lshlrev_b32 v18, 16, v18
  v_mul_f32 v19, v18, v16
  v_mul_f32 v20, v18, v17
  v_mul_f32 v19, 0x3fb8aa3b, v19
  v_mul_f32 v20, 0x3e22f983, v20
  v_exp_f32 v19, v19
  v_fract_f32 v20, v20
  v_cos_f32 v21, v20
  v_sin_f32 v22, v20
  s_nop 0
  v_mul_f32 v10, v19, v21
  v_mul_f32 v11, v19, v22
  v_mul_f32 v19, v16, v16
  v_fmac_f32 v19, v17, v17
  v_rcp_f32 v19, v19
  v_add_f32 v20, -1.0, v10
  v_mul_f32 v21, v20, v16
  v_fmac_f32 v21, v11, v17
  v_mul_f32 v22, v11, v16
  v_fma_f32 v22, -v20, v17, v22
  v_add_f32 v19, v19, v19
  v_mul_f32 v12, v21, v19
  v_mul_f32 v13, v22, v19
  v_mov_b32 v14, v10
  v_mov_b32 v15, v11
  v_mul_f32 v19, v15, v15
  v_mul_f32 v20, v14, v15
  v_fma_f32 v14, v14, v14, -v19
  v_add_f32 v15, v20, v20
  v_mul_f32 v19, v15, v15
  v_mul_f32 v20, v14, v15
  v_fma_f32 v14, v14, v14, -v19
  v_add_f32 v15, v20, v20
  v_mul_f32 v19, v15, v15
  v_mul_f32 v20, v14, v15
  v_fma_f32 v14, v14, v14, -v19
  v_add_f32 v15, v20, v20
  v_mul_f32 v19, v15, v15
  v_mul_f32 v20, v14, v15
  v_fma_f32 v14, v14, v14, -v19
  v_add_f32 v15, v20, v20
  s_lshl_b32 s30, s25, 6
  v_lshl_add_u32 v23, v1, 1, s30
  global_load_ushort v166, v23, s[72:73]
  global_load_ushort v24, v23, s[74:75]
  global_load_ushort v154, v23, s[84:85]
  s_waitcnt vmcnt(0)
  v_lshl_or_b32 v166, v24, 16, v166
L_b1pre:
  v_mov_b32 v164, v10
  v_mov_b32 v165, v11
  s_mov_b32 s47, 0
  v_mov_b32 v156, 159844
  v_mov_b32 v157, 1
  v_mov_b32 v155, 162304
  s_lshl_b32 s48, s51, 12
  s_lshl_b32 s49, s51, 11
  v_lshrrev_b32 v159, 5, v2
  v_bfe_u32 v160, v1, 1, 3
  v_xor_b32 v160, v160, v159
  v_lshlrev_b32 v161, 7, v1
  v_add_u32 v161, 16384, v161
  v_xor_b32 v162, 0, v160
  v_lshl_add_u32 v8, v162, 4, v161
  v_xor_b32 v162, 2, v160
  v_lshl_add_u32 v9, v162, 4, v161
  v_xor_b32 v162, 4, v160
  v_lshl_add_u32 v10, v162, 4, v161
  v_xor_b32 v162, 6, v160
  v_lshl_add_u32 v11, v162, 4, v161
  s_sub_u32 s30, s48, 16384
  v_add_u32 v4, s30, v8
  v_add_u32 v5, s30, v9
  v_add_u32 v6, s30, v10
  v_add_u32 v7, s30, v11
L_b1:
  v_add_u32 v148, 49152, v8
  v_add_u32 v144, 49152, v4
  v_add_u32 v149, 49152, v9
  v_add_u32 v145, 49152, v5
  v_add_u32 v150, 49152, v10
  v_add_u32 v146, 49152, v6
  v_add_u32 v151, 49152, v11
  v_add_u32 v147, 49152, v7
  s_cmp_eq_u32 s24, 2
  s_cbranch_scc1 L_pubx
  s_lshl_b32 s30, s23, 7
  s_add_u32 s31, s30, 128
  s_cmp_eq_u32 s24, 1
  s_cselect_b32 s32, 1152, 0
  v_mul_u32_u24 v160, 18, v2
  v_add_u32 v160, s32, v160
  v_add_u32 v161, 18, v160
  v_max_u32 v160, s30, v160
  v_min_u32 v161, s31, v161
  v_min_u32 v161, 0x6c0, v161
  v_cmp_lt_u32 vcc, v160, v161
  v_sub_u32 v160, v161, v160
  v_mul_u32_u24 v161, 1024, v1
  s_and_b32 s31, s22, 7
  s_lshl_b32 s31, s31, 7
  s_add_u32 s31, s31, 17843200
  s_waitcnt vmcnt(0)
  s_mov_b32 s33, 0
L_dv_37:
  v_readfirstlane_b32 s32, v153
  s_cmp_eq_u32 s32, 1
  s_cbranch_scc1 L_dv_37x
  s_add_u32 s33, s33, 1
  s_cmp_gt_u32 s33, 20000
  s_cbranch_scc1 L_dv_37x
  s_sleep 8
  global_load_dword v153, v152, s[90:91] sc0 sc1
  s_waitcnt vmcnt(0)
  s_branch L_dv_37
L_dv_37x:
  ds_write_b32 v156, v157 offset:12
  s_mov_b64 exec, 1
  ds_add_rtn_u32 v159, v156, v157 offset:4
  s_mov_b64 exec, -1
  s_waitcnt lgkmcnt(0)
  v_readfirstlane_b32 s35, v159
  s_cmp_lg_u32 s35, 3
  s_cbranch_scc1 L_pubx
  s_mov_b64 exec, vcc
  buffer_atomic_add v160, v161, s[4:7], s31 offen sc1
  s_mov_b64 exec, -1
L_pubx:
  s_mov_b32 s33, 0
L_sp_38:
  ds_read_b32 v158, v155 offset:0
  s_add_u32 s33, s33, 1
  s_waitcnt lgkmcnt(0)
  v_readfirstlane_b32 s32, v158
  s_cmp_ge_u32 s32, 4
  s_cbranch_scc1 L_sp_38x
  s_sleep 1
  s_cmp_lt_u32 s33, 320000
  s_cbranch_scc1 L_sp_38
L_sp_38x:
  ds_read_b32 v158, v155 offset:4
  ds_read_b128 v[16:19], v4 offset:0
  ds_read_b128 v[20:23], v8 offset:0
  ds_read_b128 v[24:27], v8 offset:4096
  ds_read_b128 v[28:31], v5 offset:0
  ds_read_b128 v[32:35], v9 offset:0
  ds_read_b128 v[36:39], v9 offset:4096
  ds_read_b128 v[40:43], v6 offset:0
  ds_read_b128 v[44:47], v10 offset:0
  ds_read_b128 v[48:51], v10 offset:4096
  ds_read_b128 v[52:55], v7 offset:0
  ds_read_b128 v[56:59], v11 offset:0
  ds_read_b128 v[60:63], v11 offset:4096
  s_waitcnt lgkmcnt(0)
  v_readfirstlane_b32 s32, v158
  v_mfma_f32_32x32x16_bf16 v[112:127], v[16:19], v[20:23], 0
  s_mov_b64 exec, 1
  ds_add_u32 v155, v157 offset:256
  s_mov_b64 exec, -1
  s_cmp_lt_u32 s32, 4
  s_cbranch_scc1 L_g1_0s
L_g1_0r:
  v_mfma_f32_32x32x16_bf16 v[128:143], v[16:19], v[24:27], 0
  ds_read_b128 v[64:67], v4 offset:24576
  ds_read_b128 v[68:71], v8 offset:24576
  ds_read_b128 v[72:75], v8 offset:28672
  v_mfma_f32_32x32x16_bf16 v[112:127], v[28:31], v[32:35], v[112:127]
  ds_read_b128 v[76:79], v5 offset:24576
  ds_read_b128 v[80:83], v9 offset:24576
  v_mfma_f32_32x32x16_bf16 v[128:143], v[28:31], v[36:39], v[128:143]
  ds_read_b128 v[84:87], v9 offset:28672
  ds_read_b128 v[88:91], v6 offset:24576
  v_mfma_f32_32x32x16_bf16 v[112:127], v[40:43], v[44:47], v[112:127]
  ds_read_b128 v[92:95], v10 offset:24576
  ds_read_b128 v[96:99], v10 offset:28672
  v_mfma_f32_32x32x16_bf16 v[128:143], v[40:43], v[48:51], v[128:143]
  ds_read_b128 v[100:103], v7 offset:24576
  ds_read_b128 v[104:107], v11 offset:24576
  v_mfma_f32_32x32x16_bf16 v[112:127], v[52:55], v[56:59], v[112:127]
  ds_read_b128 v[108:111], v11 offset:28672
  ds_read_b32 v158, v155 offset:8
  v_mfma_f32_32x32x16_bf16 v[128:143], v[52:55], v[60:63], v[128:143]
  s_waitcnt lgkmcnt(0)
  v_readfirstlane_b32 s32, v158
  v_mfma_f32_32x32x16_bf16 v[112:127], v[64:67], v[68:71], v[112:127]
  s_mov_b64 exec, 1
  ds_add_u32 v155, v157 offset:260
  s_mov_b64 exec, -1
  s_cmp_lt_u32 s32, 4
  s_cbranch_scc1 L_g1_1s
L_g1_1r:
  v_mfma_f32_32x32x16_bf16 v[128:143], v[64:67], v[72:75], v[128:143]
  ds_read_b128 v[16:19], v144 offset:0
  ds_read_b128 v[20:23], v148 offset:0
  ds_read_b128 v[24:27], v148 offset:4096
  v_mfma_f32_32x32x16_bf16 v[112:127], v[76:79], v[80:83], v[112:127]
  ds_read_b128 v[28:31], v145 offset:0
  ds_read_b128 v[32:35], v149 offset:0
  v_mfma_f32_32x32x16_bf16 v[128:143], v[76:79], v[84:87], v[128:143]
  ds_read_b128 v[36:39], v149 offset:4096
  ds_read_b128 v[40:43], v146 offset:0
  v_mfma_f32_32x32x16_bf16 v[112:127], v[88:91], v[92:95], v[112:127]
  ds_read_b128 v[44:47], v150 offset:0
  ds_read_b128 v[48:51], v150 offset:4096
  v_mfma_f32_32x32x16_bf16 v[128:143], v[88:91], v[96:99], v[128:143]
  ds_read_b128 v[52:55], v147 offset:0
  ds_read_b128 v[56:59], v151 offset:0
  v_mfma_f32_32x32x16_bf16 v[112:127], v[100:103], v[104:107], v[112:127]
  ds_read_b128 v[60:63], v151 offset:4096
  ds_read_b32 v158, v155 offset:12
  v_mfma_f32_32x32x16_bf16 v[128:143], v[100:103], v[108:111], v[128:143]
  s_waitcnt lgkmcnt(0)
  v_readfirstlane_b32 s32, v158
  v_mfma_f32_32x32x16_bf16 v[112:127], v[16:19], v[20:23], v[112:127]
  s_mov_b64 exec, 1
  ds_add_u32 v155, v157 offset:264
  s_mov_b64 exec, -1
  s_cmp_lt_u32 s32, 4
  s_cbranch_scc1 L_g1_2s
L_g1_2r:
  v_mfma_f32_32x32x16_bf16 v[128:143], v[16:19], v[24:27], v[128:143]
  ds_read_b128 v[64:67], v144 offset:24576
  ds_read_b128 v[68:71], v148 offset:24576
  ds_read_b128 v[72:75], v148 offset:28672
  v_mfma_f32_32x32x16_bf16 v[112:127], v[28:31], v[32:35], v[112:127]
  ds_read_b128 v[76:79], v145 offset:24576
  ds_read_b128 v[80:83], v149 offset:24576
  v_mfma_f32_32x32x16_bf16 v[128:143], v[28:31], v[36:39], v[128:143]
  ds_read_b128 v[84:87], v149 offset:28672
  ds_read_b128 v[88:91], v146 offset:24576
  v_mfma_f32_32x32x16_bf16 v[112:127], v[40:43], v[44:47], v[112:127]
  ds_read_b128 v[92:95], v150 offset:24576
  ds_read_b128 v[96:99], v150 offset:28672
  v_mfma_f32_32x32x16_bf16 v[128:143], v[40:43], v[48:51], v[128:143]
  ds_read_b128 v[100:103], v147 offset:24576
  ds_read_b128 v[104:107], v151 offset:24576
  v_mfma_f32_32x32x16_bf16 v[112:127], v[52:55], v[56:59], v[112:127]
  ds_read_b128 v[108:111], v151 offset:28672
  ds_read_b32 v158, v155 offset:16
  v_mfma_f32_32x32x16_bf16 v[128:143], v[52:55], v[60:63], v[128:143]
  s_waitcnt lgkmcnt(0)
  v_readfirstlane_b32 s32, v158
  v_mfma_f32_32x32x16_bf16 v[112:127], v[64:67], v[68:71], v[112:127]
  s_mov_b64 exec, 1
  ds_add_u32 v155, v157 offset:268
  s_mov_b64 exec, -1
  s_cmp_lt_u32 s32, 4
  s_cbranch_scc1 L_g1_3s
L_g1_3r:
  v_mfma_f32_32x32x16_bf16 v[128:143], v[64:67], v[72:75], v[128:143]
  ds_read_b128 v[16:19], v4 offset:0
  ds_read_b128 v[20:23], v8 offset:0
  ds_read_b128 v[24:27], v8 offset:4096
  v_mfma_f32_32x32x16_bf16 v[112:127], v[76:79], v[80:83], v[112:127]
  ds_read_b128 v[28:31], v5 offset:0
  ds_read_b128 v[32:35], v9 offset:0
  v_mfma_f32_32x32x16_bf16 v[128:143], v[76:79], v[84:87], v[128:143]
  ds_read_b128 v[36:39], v9 offset:4096
  ds_read_b128 v[40:43], v6 offset:0
  v_mfma_f32_32x32x16_bf16 v[112:127], v[88:91], v[92:95], v[112:127]
  ds_read_b128 v[44:47], v10 offset:0
  ds_read_b128 v[48:51], v10 offset:4096
  v_mfma_f32_32x32x16_bf16 v[128:143], v[88:91], v[96:99], v[128:143]
  ds_read_b128 v[52:55], v7 offset:0
  ds_read_b128 v[56:59], v11 offset:0
  v_mfma_f32_32x32x16_bf16 v[112:127], v[100:103], v[104:107], v[112:127]
  ds_read_b128 v[60:63], v11 offset:4096
  ds_read_b32 v158, v155 offset:20
  v_mfma_f32_32x32x16_bf16 v[128:143], v[100:103], v[108:111], v[128:143]
  s_add_u32 s30, s24, s27
  s_cmp_lg_u32 s30, 3
  s_cbranch_scc1 L_sph
  s_cmp_lg_u32 s3, 3
  s_cbranch_scc1 L_sph
  s_lshl_b32 s30, s26, 5
  s_add_u32 s30, s30, s22
  s_lshl_b32 s30, s30, 2
  s_add_u32 s30, s30, 17825792
  s_waitcnt vmcnt(0)
  v_mov_b32 v160, 0
  v_mov_b32 v161, 1
  s_mov_b64 exec, 1
  buffer_store_dword v161, v160, s[4:7], s30 offen sc0 sc1
  s_mov_b64 exec, -1
L_sph:
  s_waitcnt lgkmcnt(0)
  v_readfirstlane_b32 s32, v158
  v_mfma_f32_32x32x16_bf16 v[112:127], v[16:19], v[20:23], v[112:127]
  s_mov_b64 exec, 1
  ds_add_u32 v155, v157 offset:272
  s_mov_b64 exec, -1
  s_cmp_lt_u32 s32, 4
  s_cbranch_scc1 L_g1_4s
L_g1_4r:
  v_mfma_f32_32x32x16_bf16 v[128:143], v[16:19], v[24:27], v[128:143]
  ds_read_b128 v[64:67], v4 offset:24576
  ds_read_b128 v[68:71], v8 offset:24576
  ds_read_b128 v[72:75], v8 offset:28672
  v_mfma_f32_32x32x16_bf16 v[112:127], v[28:31], v[32:35], v[112:127]
  ds_read_b128 v[76:79], v5 offset:24576
  ds_read_b128 v[80:83], v9 offset:24576
  v_mfma_f32_32x32x16_bf16 v[128:143], v[28:31], v[36:39], v[128:143]
  ds_read_b128 v[84:87], v9 offset:28672
  ds_read_b128 v[88:91], v6 offset:24576
  v_mfma_f32_32x32x16_bf16 v[112:127], v[40:43], v[44:47], v[112:127]
  ds_read_b128 v[92:95], v10 offset:24576
  ds_read_b128 v[96:99], v10 offset:28672
  v_mfma_f32_32x32x16_bf16 v[128:143], v[40:43], v[48:51], v[128:143]
  ds_read_b128 v[100:103], v7 offset:24576
  ds_read_b128 v[104:107], v11 offset:24576
  v_mfma_f32_32x32x16_bf16 v[112:127], v[52:55], v[56:59], v[112:127]
  ds_read_b128 v[108:111], v11 offset:28672
  ds_read_b32 v158, v155 offset:24
  v_mfma_f32_32x32x16_bf16 v[128:143], v[52:55], v[60:63], v[128:143]
  s_waitcnt lgkmcnt(0)
  v_readfirstlane_b32 s32, v158
  v_mfma_f32_32x32x16_bf16 v[112:127], v[64:67], v[68:71], v[112:127]
  s_mov_b64 exec, 1
  ds_add_u32 v155, v157 offset:276
  s_mov_b64 exec, -1
  s_cmp_lt_u32 s32, 4
  s_cbranch_scc1 L_g1_5s
L_g1_5r:
  v_mfma_f32_32x32x16_bf16 v[128:143], v[64:67], v[72:75], v[128:143]
  ds_read_b128 v[16:19], v144 offset:0
  ds_read_b128 v[20:23], v148 offset:0
  ds_read_b128 v[24:27], v148 offset:4096
  v_mfma_f32_32x32x16_bf16 v[112:127], v[76:79], v[80:83], v[112:127]
  ds_read_b128 v[28:31], v145 offset:0
  ds_read_b128 v[32:35], v149 offset:0
  v_mfma_f32_32x32x16_bf16 v[128:143], v[76:79], v[84:87], v[128:143]
  ds_read_b128 v[36:39], v149 offset:4096
  ds_read_b128 v[40:43], v146 offset:0
  v_mfma_f32_32x32x16_bf16 v[112:127], v[88:91], v[92:95], v[112:127]
  ds_read_b128 v[44:47], v150 offset:0
  ds_read_b128 v[48:51], v150 offset:4096
  v_mfma_f32_32x32x16_bf16 v[128:143], v[88:91], v[96:99], v[128:143]
  ds_read_b128 v[52:55], v147 offset:0
  ds_read_b128 v[56:59], v151 offset:0
  v_mfma_f32_32x32x16_bf16 v[112:127], v[100:103], v[104:107], v[112:127]
  ds_read_b128 v[60:63], v151 offset:4096
  ds_read_b32 v158, v155 offset:28
  v_mfma_f32_32x32x16_bf16 v[128:143], v[100:103], v[108:111], v[128:143]
  s_cmp_lg_u32 s27, 0
  s_cbranch_scc1 L_h5
  v_mov_b32 v152, 0
  global_load_dword v153, v152, s[90:91]
L_h5:
  s_waitcnt lgkmcnt(0)
  v_readfirstlane_b32 s32, v158
  v_mfma_f32_32x32x16_bf16 v[112:127], v[16:19], v[20:23], v[112:127]
  s_mov_b64 exec, 1
  ds_add_u32 v155, v157 offset:280
  s_mov_b64 exec, -1
  s_cmp_lt_u32 s32, 4
  s_cbranch_scc1 L_g1_6s
L_g1_6r:
  v_mfma_f32_32x32x16_bf16 v[128:143], v[16:19], v[24:27], v[128:143]
  ds_read_b128 v[64:67], v144 offset:24576
  ds_read_b128 v[68:71], v148 offset:24576
  ds_read_b128 v[72:75], v148 offset:28672
  v_mfma_f32_32x32x16_bf16 v[112:127], v[28:31], v[32:35], v[112:127]
  ds_read_b128 v[76:79], v145 offset:24576
  ds_read_b128 v[80:83], v149 offset:24576
  v_mfma_f32_32x32x16_bf16 v[128:143], v[28:31], v[36:39], v[128:143]
  ds_read_b128 v[84:87], v149 offset:28672
  ds_read_b128 v[88:91], v146 offset:24576
  v_mfma_f32_32x32x16_bf16 v[112:127], v[40:43], v[44:47], v[112:127]
  ds_read_b128 v[92:95], v150 offset:24576
  ds_read_b128 v[96:99], v150 offset:28672
  v_mfma_f32_32x32x16_bf16 v[128:143], v[40:43], v[48:51], v[128:143]
  ds_read_b128 v[100:103], v147 offset:24576
  ds_read_b128 v[104:107], v151 offset:24576
  v_mfma_f32_32x32x16_bf16 v[112:127], v[52:55], v[56:59], v[112:127]
  ds_read_b128 v[108:111], v151 offset:28672
  ds_read_b32 v158, v155 offset:32
  v_mfma_f32_32x32x16_bf16 v[128:143], v[52:55], v[60:63], v[128:143]
  s_waitcnt lgkmcnt(0)
  v_readfirstlane_b32 s32, v158
  v_mfma_f32_32x32x16_bf16 v[112:127], v[64:67], v[68:71], v[112:127]
  s_mov_b64 exec, 1
  ds_add_u32 v155, v157 offset:284
  s_mov_b64 exec, -1
  s_cmp_lt_u32 s32, 4
  s_cbranch_scc1 L_g1_7s
L_g1_7r:
  v_mfma_f32_32x32x16_bf16 v[128:143], v[64:67], v[72:75], v[128:143]
  ds_read_b128 v[16:19], v4 offset:0
  ds_read_b128 v[20:23], v8 offset:0
  v_mfma_f32_32x32x16_bf16 v[112:127], v[76:79], v[80:83], v[112:127]
  ds_read_b128 v[24:27], v8 offset:4096
  ds_read_b128 v[28:31], v5 offset:0
  v_mfma_f32_32x32x16_bf16 v[128:143], v[76:79], v[84:87], v[128:143]
  ds_read_b128 v[32:35], v9 offset:0
  ds_read_b128 v[36:39], v9 offset:4096
  v_mfma_f32_32x32x16_bf16 v[112:127], v[88:91], v[92:95], v[112:127]
  ds_read_b128 v[40:43], v6 offset:0
  ds_read_b128 v[44:47], v10 offset:0
  v_mfma_f32_32x32x16_bf16 v[128:143], v[88:91], v[96:99], v[128:143]
  ds_read_b128 v[48:51], v10 offset:4096
  ds_read_b128 v[52:55], v7 offset:0
  v_mfma_f32_32x32x16_bf16 v[112:127], v[100:103], v[104:107], v[112:127]
  ds_read_b128 v[56:59], v11 offset:0
  ds_read_b128 v[60:63], v11 offset:4096
  v_mfma_f32_32x32x16_bf16 v[128:143], v[100:103], v[108:111], v[128:143]
  s_cmp_lg_u32 s27, 0
  s_cbranch_scc1 L_h7
  s_waitcnt vmcnt(0)
  s_mov_b32 s33, 0
L_dv_39:
  v_readfirstlane_b32 s32, v153
  s_cmp_eq_u32 s32, 1
  s_cbranch_scc1 L_dv_39x
  s_add_u32 s33, s33, 1
  s_cmp_gt_u32 s33, 20000
  s_cbranch_scc1 L_dv_39x
  s_sleep 8
  global_load_dword v153, v152, s[90:91] sc0 sc1
  s_waitcnt vmcnt(0)
  s_branch L_dv_39
L_dv_39x:
  ds_write_b32 v156, v157 offset:12
L_h7:
  s_waitcnt lgkmcnt(0)
  s_mov_b64 exec, 1
  ds_add_u32 v155, v157 offset:288
  s_mov_b64 exec, -1
  v_mfma_f32_32x32x16_bf16 v[112:127], v[16:19], v[20:23], v[112:127]
  v_mfma_f32_32x32x16_bf16 v[128:143], v[16:19], v[24:27], v[128:143]
  v_mfma_f32_32x32x16_bf16 v[112:127], v[28:31], v[32:35], v[112:127]
  v_mfma_f32_32x32x16_bf16 v[128:143], v[28:31], v[36:39], v[128:143]
  v_mfma_f32_32x32x16_bf16 v[112:127], v[40:43], v[44:47], v[112:127]
  v_mfma_f32_32x32x16_bf16 v[128:143], v[40:43], v[48:51], v[128:143]
  v_mfma_f32_32x32x16_bf16 v[112:127], v[52:55], v[56:59], v[112:127]
  v_mfma_f32_32x32x16_bf16 v[128:143], v[52:55], v[60:63], v[128:143]
  v_add_u32 v155, 36, v155
  s_nop 4
  v_mov_b32 v96, v164
  v_mov_b32 v97, v165
  v_mov_b32 v98, v12
  v_mov_b32 v99, v13
  v_mov_b32 v104, v14
  v_mov_b32 v105, v15
  v_mul_f32 v64, v98, v112
  v_mul_f32 v65, v98, v128
  v_fma_f32 v64, -v99, v128, v64
  v_fma_f32 v65, v99, v112, v65
  v_mul_f32 v66, v98, v113
  v_mul_f32 v67, v98, v129
  v_fma_f32 v66, -v99, v129, v66
  v_fma_f32 v67, v99, v113, v67
  v_pk_fma_f32 v[160:161], v[96:97], v[64:65], v[66:67] op_sel_hi:[0,1,1]
  v_pk_fma_f32 v[160:161], v[96:97], v[64:65], v[160:161] op_sel:[1,1,0] op_sel_hi:[1,0,1] neg_lo:[1,0,0]
  v_mul_f32 v68, v98, v114
  v_mul_f32 v69, v98, v130
  v_fma_f32 v68, -v99, v130, v68
  v_fma_f32 v69, v99, v114, v69
  v_pk_fma_f32 v[162:163], v[96:97], v[160:161], v[68:69] op_sel_hi:[0,1,1]
  v_pk_fma_f32 v[162:163], v[96:97], v[160:161], v[162:163] op_sel:[1,1,0] op_sel_hi:[1,0,1] neg_lo:[1,0,0]
  v_mul_f32 v70, v98, v115
  v_mul_f32 v71, v98, v131
  v_fma_f32 v70, -v99, v131, v70
  v_fma_f32 v71, v99, v115, v71
  v_pk_fma_f32 v[160:161], v[96:97], v[162:163], v[70:71] op_sel_hi:[0,1,1]
  v_pk_fma_f32 v[160:161], v[96:97], v[162:163], v[160:161] op_sel:[1,1,0] op_sel_hi:[1,0,1] neg_lo:[1,0,0]
  v_mul_f32 v72, v98, v116
  v_mul_f32 v73, v98, v132
  v_fma_f32 v72, -v99, v132, v72
  v_fma_f32 v73, v99, v116, v73
  v_pk_fma_f32 v[162:163], v[96:97], v[160:161], v[72:73] op_sel_hi:[0,1,1]
  v_pk_fma_f32 v[162:163], v[96:97], v[160:161], v[162:163] op_sel:[1,1,0] op_sel_hi:[1,0,1] neg_lo:[1,0,0]
  v_mul_f32 v74, v98, v117
  v_mul_f32 v75, v98, v133
  v_fma_f32 v74, -v99, v133, v74
  v_fma_f32 v75, v99, v117, v75
  v_pk_fma_f32 v[160:161], v[96:97], v[162:163], v[74:75] op_sel_hi:[0,1,1]
  v_pk_fma_f32 v[160:161], v[96:97], v[162:163], v[160:161] op_sel:[1,1,0] op_sel_hi:[1,0,1] neg_lo:[1,0,0]
  v_mul_f32 v76, v98, v118
  v_mul_f32 v77, v98, v134
  v_fma_f32 v76, -v99, v134, v76
  v_fma_f32 v77, v99, v118, v77
  v_pk_fma_f32 v[162:163], v[96:97], v[160:161], v[76:77] op_sel_hi:[0,1,1]
  v_pk_fma_f32 v[162:163], v[96:97], v[160:161], v[162:163] op_sel:[1,1,0] op_sel_hi:[1,0,1] neg_lo:[1,0,0]
  v_mul_f32 v78, v98, v119
  v_mul_f32 v79, v98, v135
  v_fma_f32 v78, -v99, v135, v78
  v_fma_f32 v79, v99, v119, v79
  v_pk_fma_f32 v[160:161], v[96:97], v[162:163], v[78:79] op_sel_hi:[0,1,1]
  v_pk_fma_f32 v[160:161], v[96:97], v[162:163], v[160:161] op_sel:[1,1,0] op_sel_hi:[1,0,1] neg_lo:[1,0,0]
  v_mul_f32 v80, v98, v120
  v_mul_f32 v81, v98, v136
  v_fma_f32 v80, -v99, v136, v80
  v_fma_f32 v81, v99, v120, v81
  v_pk_fma_f32 v[162:163], v[96:97], v[160:161], v[80:81] op_sel_hi:[0,1,1]
  v_pk_fma_f32 v[162:163], v[96:97], v[160:161], v[162:163] op_sel:[1,1,0] op_sel_hi:[1,0,1] neg_lo:[1,0,0]
  v_mul_f32 v82, v98, v121
  v_mul_f32 v83, v98, v137
  v_fma_f32 v82, -v99, v137, v82
  v_fma_f32 v83, v99, v121, v83
  v_pk_fma_f32 v[160:161], v[96:97], v[162:163], v[82:83] op_sel_hi:[0,1,1]
  v_pk_fma_f32 v[160:161], v[96:97], v[162:163], v[160:161] op_sel:[1,1,0] op_sel_hi:[1,0,1] neg_lo:[1,0,0]
  v_mul_f32 v84, v98, v122
  v_mul_f32 v85, v98, v138
  v_fma_f32 v84, -v99, v138, v84
  v_fma_f32 v85, v99, v122, v85
  v_pk_fma_f32 v[162:163], v[96:97], v[160:161], v[84:85] op_sel_hi:[0,1,1]
  v_pk_fma_f32 v[162:163], v[96:97], v[160:161], v[162:163] op_sel:[1,1,0] op_sel_hi:[1,0,1] neg_lo:[1,0,0]
  v_mul_f32 v86, v98, v123
  v_mul_f32 v87, v98, v139
  v_fma_f32 v86, -v99, v139, v86
  v_fma_f32 v87, v99, v123, v87
  v_pk_fma_f32 v[160:161], v[96:97], v[162:163], v[86:87] op_sel_hi:[0,1,1]
  v_pk_fma_f32 v[160:161], v[96:97], v[162:163], v[160:161] op_sel:[1,1,0] op_sel_hi:[1,0,1] neg_lo:[1,0,0]
  v_mul_f32 v88, v98, v124
  v_mul_f32 v89, v98, v140
  v_fma_f32 v88, -v99, v140, v88
  v_fma_f32 v89, v99, v124, v89
  v_pk_fma_f32 v[162:163], v[96:97], v[160:161], v[88:89] op_sel_hi:[0,1,1]
  v_pk_fma_f32 v[162:163], v[96:97], v[160:161], v[162:163] op_sel:[1,1,0] op_sel_hi:[1,0,1] neg_lo:[1,0,0]
  v_mul_f32 v90, v98, v125
  v_mul_f32 v91, v98, v141
  v_fma_f32 v90, -v99, v141, v90
  v_fma_f32 v91, v99, v125, v91
  v_pk_fma_f32 v[160:161], v[96:97], v[162:163], v[90:91] op_sel_hi:[0,1,1]
  v_pk_fma_f32 v[160:161], v[96:97], v[162:163], v[160:161] op_sel:[1,1,0] op_sel_hi:[1,0,1] neg_lo:[1,0,0]
  v_mul_f32 v92, v98, v126
  v_mul_f32 v93, v98, v142
  v_fma_f32 v92, -v99, v142, v92
  v_fma_f32 v93, v99, v126, v93
  v_pk_fma_f32 v[162:163], v[96:97], v[160:161], v[92:93] op_sel_hi:[0,1,1]
  v_pk_fma_f32 v[162:163], v[96:97], v[160:161], v[162:163] op_sel:[1,1,0] op_sel_hi:[1,0,1] neg_lo:[1,0,0]
  v_mul_f32 v94, v98, v127
  v_mul_f32 v95, v98, v143
  v_fma_f32 v94, -v99, v143, v94
  v_fma_f32 v95, v99, v127, v95
  v_pk_fma_f32 v[160:161], v[96:97], v[162:163], v[94:95] op_sel_hi:[0,1,1]
  v_pk_fma_f32 v[160:161], v[96:97], v[162:163], v[160:161] op_sel:[1,1,0] op_sel_hi:[1,0,1] neg_lo:[1,0,0]
  s_lshl_b32 s31, s3, 9
  s_add_u32 s30, s31, 160256
  v_lshl_add_u32 v162, v2, 3, s30
  ds_write_b64 v162, v[160:161]
  v_lshlrev_b32 v163, 3, v2
  v_add_u32 v163, 160000, v163
  s_add_u32 s47, s47, 4
  s_mov_b64 exec, 1
  ds_add_u32 v156, v157 offset:0
  s_mov_b64 exec, -1
  s_mov_b32 s33, 0
L_sp_40:
  ds_read_b32 v158, v156 offset:0
  s_add_u32 s33, s33, 1
  s_waitcnt lgkmcnt(0)
  v_readfirstlane_b32 s32, v158
  s_cmp_ge_u32 s32, s47
  s_cbranch_scc1 L_sp_40x
  s_cmp_lt_u32 s33, 320000
  s_cbranch_scc1 L_sp_40
L_sp_40x:
  ds_read_b64 v[16:17], v163 offset:0
  ds_read_b64 v[18:19], v163 offset:256
  ds_read_b64 v[20:21], v163 offset:512
  ds_read_b64 v[22:23], v163 offset:768
  ds_read_b64 v[24:25], v163 offset:1024
  ds_read_b64 v[26:27], v163 offset:1280
  ds_read_b64 v[28:29], v163 offset:1536
  ds_read_b64 v[30:31], v163 offset:1792
  s_waitcnt lgkmcnt(0)
  v_cndmask_b32 v100, 0, v16, s[62:63]
  v_cndmask_b32 v101, 0, v17, s[62:63]
  v_cndmask_b32 v102, 1.0, v104, s[62:63]
  v_cndmask_b32 v103, 0, v105, s[62:63]
  s_cmp_lt_u32 s3, 1
  s_cbranch_scc1 L_pbne
  v_mul_f32 v158, v104, v102
  v_mul_f32 v159, v104, v103
  v_fma_f32 v160, v104, v100, v18
  v_fma_f32 v161, v104, v101, v19
  v_fma_f32 v158, -v105, v103, v158
  v_fma_f32 v103, v105, v102, v159
  v_fma_f32 v160, -v105, v101, v160
  v_fma_f32 v101, v105, v100, v161
  v_mov_b32 v102, v158
  v_mov_b32 v100, v160
  v_mul_f32 v158, v104, v102
  v_mul_f32 v159, v104, v103
  v_fma_f32 v160, v104, v100, v20
  v_fma_f32 v161, v104, v101, v21
  v_fma_f32 v158, -v105, v103, v158
  v_fma_f32 v103, v105, v102, v159
  v_fma_f32 v160, -v105, v101, v160
  v_fma_f32 v101, v105, v100, v161
  v_mov_b32 v102, v158
  v_mov_b32 v100, v160
  s_cmp_lt_u32 s3, 2
  s_cbranch_scc1 L_pbne
  v_mul_f32 v158, v104, v102
  v_mul_f32 v159, v104, v103
  v_fma_f32 v160, v104, v100, v22
  v_fma_f32 v161, v104, v101, v23
  v_fma_f32 v158, -v105, v103, v158
  v_fma_f32 v103, v105, v102, v159
  v_fma_f32 v160, -v105, v101, v160
  v_fma_f32 v101, v105, v100, v161
  v_mov_b32 v102, v158
  v_mov_b32 v100, v160
  v_mul_f32 v158, v104, v102
  v_mul_f32 v159, v104, v103
  v_fma_f32 v160, v104, v100, v24
  v_fma_f32 v161, v104, v101, v25
  v_fma_f32 v158, -v105, v103, v158
  v_fma_f32 v103, v105, v102, v159
  v_fma_f32 v160, -v105, v101, v160
  v_fma_f32 v101, v105, v100, v161
  v_mov_b32 v102, v158
  v_mov_b32 v100, v160
  s_cmp_lt_u32 s3, 3
  s_cbranch_scc1 L_pbne
  v_mul_f32 v158, v104, v102
  v_mul_f32 v159, v104, v103
  v_fma_f32 v160, v104, v100, v26
  v_fma_f32 v161, v104, v101, v27
  v_fma_f32 v158, -v105, v103, v158
  v_fma_f32 v103, v105, v102, v159
  v_fma_f32 v160, -v105, v101, v160
  v_fma_f32 v101, v105, v100, v161
  v_mov_b32 v102, v158
  v_mov_b32 v100, v160
  v_mul_f32 v158, v104, v102
  v_mul_f32 v159, v104, v103
  v_fma_f32 v160, v104, v100, v28
  v_fma_f32 v161, v104, v101, v29
  v_fma_f32 v158, -v105, v103, v158
  v_fma_f32 v103, v105, v102, v159
  v_fma_f32 v160, -v105, v101, v160
  v_fma_f32 v101, v105, v100, v161
  v_mov_b32 v102, v158
  v_mov_b32 v100, v160
  s_mul_i32 s30, s22, 4608
  s_lshl_b32 s31, s29, 8
  s_add_u32 s30, s30, s31
  s_add_u32 s30, s30, 16776960
  v_lshlrev_b32 v160, 3, v2
  v_fma_f32 v158, v104, v100, v30
  v_fma_f32 v159, v104, v101, v31
  v_fma_f32 v158, -v105, v101, v158
  v_fma_f32 v159, v105, v100, v159
  s_mov_b32 exec_lo, 0
  buffer_store_dwordx2 v[158:159], v160, s[4:7], s30 offen sc0 sc1
  s_mov_b32 exec_lo, -1
  s_cmp_eq_u32 s27, 0
  s_cbranch_scc1 L_pbne
  s_lshl_b32 s30, s29, 5
  s_add_u32 s30, s30, s22
  s_lshl_b32 s30, s30, 2
  s_add_u32 s30, s30, 17825792
  s_waitcnt vmcnt(0)
  v_mov_b32 v158, 0
  v_mov_b32 v159, 1
  s_mov_b64 exec, 1
  buffer_store_dword v159, v158, s[4:7], s30 offen sc0 sc1
  s_mov_b64 exec, -1
L_pbne:
  v_mul_f32 v162, v105, v105
  v_mul_f32 v163, v104, v105
  v_fma_f32 v104, v104, v104, -v162
  v_add_f32 v105, v163, v163
  v_mul_f32 v162, v105, v105
  v_mul_f32 v163, v104, v105
  v_fma_f32 v104, v104, v104, -v162
  v_add_f32 v105, v163, v163
  v_mul_f32 v162, v105, v105
  v_mul_f32 v163, v104, v105
  v_fma_f32 v104, v104, v104, -v162
  v_add_f32 v105, v163, v163
  s_cmp_lg_u32 s27, 0
  s_cbranch_scc1 L_b1done
  s_lshl_b32 s30, s2, 2
  s_add_u32 s30, s30, s3
  s_mul_i32 s30, s30, 12288
  s_add_u32 s30, s30, 18874368
  buffer_store_dwordx4 v[64:67], v3, s[4:7], s30 offen offset:0
  buffer_store_dwordx4 v[68:71], v3, s[4:7], s30 offen offset:1024
  buffer_store_dwordx4 v[72:75], v3, s[4:7], s30 offen offset:2048
  buffer_store_dwordx4 v[76:79], v3, s[4:7], s30 offen offset:3072
  s_add_u32 s30, s30, 4096
  buffer_store_dwordx4 v[80:83], v3, s[4:7], s30 offen offset:0
  buffer_store_dwordx4 v[84:87], v3, s[4:7], s30 offen offset:1024
  buffer_store_dwordx4 v[88:91], v3, s[4:7], s30 offen offset:2048
  buffer_store_dwordx4 v[92:95], v3, s[4:7], s30 offen offset:3072
  s_add_u32 s30, s30, 4096
  buffer_store_dwordx4 v[96:99], v3, s[4:7], s30 offen offset:0
  buffer_store_dwordx4 v[100:103], v3, s[4:7], s30 offen offset:1024
  buffer_store_dwordx2 v[104:105], v3, s[4:7], s30 offen offset:2048
  v_and_b32 v16, 0xffff, v166
  v_lshrrev_b32 v17, 16, v166
  v_mov_b32 v18, v154
  v_lshlrev_b32 v16, 16, v16
  v_lshlrev_b32 v17, 16, v17
  v_lshlrev_b32 v18, 16, v18
  v_mul_f32 v18, 0x3fb8aa3b, v18
  v_exp_f32 v18, v18
  s_nop 0
  v_cvt_pk_bf16_f32 v18, v18, v18
  v_lshlrev_b32 v18, 16, v18
  v_mul_f32 v19, v18, v16
  v_mul_f32 v20, v18, v17
  v_mul_f32 v19, 0x3fb8aa3b, v19
  v_mul_f32 v20, 0x3e22f983, v20
  v_exp_f32 v19, v19
  v_fract_f32 v20, v20
  v_cos_f32 v21, v20
  v_sin_f32 v22, v20
  s_nop 0
  v_mul_f32 v10, v19, v21
  v_mul_f32 v11, v19, v22
  v_mul_f32 v19, v16, v16
  v_fmac_f32 v19, v17, v17
  v_rcp_f32 v19, v19
  v_add_f32 v20, -1.0, v10
  v_mul_f32 v21, v20, v16
  v_fmac_f32 v21, v11, v17
  v_mul_f32 v22, v11, v16
  v_fma_f32 v22, -v20, v17, v22
  v_add_f32 v19, v19, v19
  v_mul_f32 v12, v21, v19
  v_mul_f32 v13, v22, v19
  v_mov_b32 v14, v10
  v_mov_b32 v15, v11
  v_mul_f32 v19, v15, v15
  v_mul_f32 v20, v14, v15
  v_fma_f32 v14, v14, v14, -v19
  v_add_f32 v15, v20, v20
  v_mul_f32 v19, v15, v15
  v_mul_f32 v20, v14, v15
  v_fma_f32 v14, v14, v14, -v19
  v_add_f32 v15, v20, v20
  v_mul_f32 v19, v15, v15
  v_mul_f32 v20, v14, v15
  v_fma_f32 v14, v14, v14, -v19
  v_add_f32 v15, v20, v20
  v_mul_f32 v19, v15, v15
  v_mul_f32 v20, v14, v15
  v_fma_f32 v14, v14, v14, -v19
  v_add_f32 v15, v20, v20
  v_mov_b32 v164, v10
  v_mov_b32 v165, v11
  v_lshrrev_b32 v159, 5, v2
  v_bfe_u32 v160, v1, 1, 3
  v_xor_b32 v160, v160, v159
  v_lshlrev_b32 v161, 7, v1
  v_add_u32 v161, 16384, v161
  v_xor_b32 v162, 0, v160
  v_lshl_add_u32 v8, v162, 4, v161
  v_xor_b32 v162, 2, v160
  v_lshl_add_u32 v9, v162, 4, v161
  v_xor_b32 v162, 4, v160
  v_lshl_add_u32 v10, v162, 4, v161
  v_xor_b32 v162, 6, v160
  v_lshl_add_u32 v11, v162, 4, v161
  s_mov_b32 s27, 1
  s_mov_b32 s29, s25
  s_branch L_b1
L_b1done:
  s_add_u32 s46, s48, 100352
  s_cmp_lg_u32 s24, 2
  s_cbranch_scc1 L_nsp
  s_lshl_b32 s30, s2, 2
  s_add_u32 s30, s30, s3
  s_mul_i32 s30, s30, 12288
  s_add_u32 s30, s30, 18874368
  buffer_load_dwordx4 v[108:111], v3, s[4:7], s30 offen offset:0
  buffer_load_dwordx4 v[112:115], v3, s[4:7], s30 offen offset:1024
  buffer_load_dwordx4 v[116:119], v3, s[4:7], s30 offen offset:2048
  buffer_load_dwordx4 v[120:123], v3, s[4:7], s30 offen offset:3072
  s_add_u32 s30, s30, 4096
  buffer_load_dwordx4 v[124:127], v3, s[4:7], s30 offen offset:0
  buffer_load_dwordx4 v[128:131], v3, s[4:7], s30 offen offset:1024
  buffer_load_dwordx4 v[132:135], v3, s[4:7], s30 offen offset:2048
  buffer_load_dwordx4 v[136:139], v3, s[4:7], s30 offen offset:3072
  s_add_u32 s30, s30, 4096
  buffer_load_dwordx4 v[140:143], v3, s[4:7], s30 offen offset:0
  buffer_load_dwordx4 v[144:147], v3, s[4:7], s30 offen offset:1024
  buffer_load_dwordx2 v[148:149], v3, s[4:7], s30 offen offset:2048
L_nsp:
  v_and_b32 v158, 3, v2
  v_lshlrev_b32 v158, 2, v158
  v_add_u32 v158, 159808, v158
  s_mov_b32 s33, 0
  s_mov_b32 s30, 1342177280
L_pg_41:
  ds_read_b32 v159, v158
  s_add_u32 s33, s33, 1
  s_waitcnt lgkmcnt(0)
  v_cmp_gt_u32 vcc, 159748, v159
  s_cmp_gt_u32 s33, 160000
  s_cbranch_scc1 L_pg_41x
  s_cbranch_vccz L_pg_41x
  s_sleep 4
  s_branch L_pg_41
L_pg_41x:
L_p2:
  s_cmp_eq_u32 s22, 0
  s_cbranch_scc1 L_pollF2_x
  s_sub_u32 s35, s22, 1
  v_min_u32 v162, s35, v2
  v_lshlrev_b32 v162, 2, v162
  s_lshl_b32 s34, s29, 7
  s_add_u32 s34, s34, 17825792
  s_mov_b32 s33, 0
L_pollF2:
  buffer_load_dword v160, v162, s[4:7], s34 offen sc0 sc1
  s_waitcnt vmcnt(0)
  v_cmp_ne_u32 vcc, 1, v160
  s_add_u32 s33, s33, 1
  s_cmp_gt_u32 s33, 20000
  s_cbranch_scc1 L_pollF2_x
  s_cbranch_vccz L_pollF2_x
  s_sleep 4
  s_branch L_pollF2
L_pollF2_x:
  s_add_u32 s8, s92, 16777216
  s_addc_u32 s9, s93, 0
  s_and_b32 s9, s9, 0xffff
  s_mov_b32 s10, 73728
  s_mov_b32 s11, 0x20000
  v_lshrrev_b32 v160, 5, v2
  v_mul_u32_u24 v160, 4608, v160
  v_lshlrev_b32 v162, 3, v1
  v_sub_u32 v162, v162, v160
  s_sub_u32 s34, s22, 1
  s_mul_i32 s34, s34, 4608
  v_add_u32 v162, s34, v162
  s_lshl_b32 s34, s29, 8
  buffer_load_dwordx2 v[16:17], v162, s[8:11], s34 offen sc0 sc1
  v_subrev_u32 v162, 9216, v162
  buffer_load_dwordx2 v[18:19], v162, s[8:11], s34 offen sc0 sc1
  v_subrev_u32 v162, 9216, v162
  buffer_load_dwordx2 v[20:21], v162, s[8:11], s34 offen sc0 sc1
  v_subrev_u32 v162, 9216, v162
  buffer_load_dwordx2 v[22:23], v162, s[8:11], s34 offen sc0 sc1
  v_subrev_u32 v162, 9216, v162
  buffer_load_dwordx2 v[24:25], v162, s[8:11], s34 offen sc0 sc1
  v_subrev_u32 v162, 9216, v162
  buffer_load_dwordx2 v[26:27], v162, s[8:11], s34 offen sc0 sc1
  v_subrev_u32 v162, 9216, v162
  buffer_load_dwordx2 v[28:29], v162, s[8:11], s34 offen sc0 sc1
  v_subrev_u32 v162, 9216, v162
  buffer_load_dwordx2 v[30:31], v162, s[8:11], s34 offen sc0 sc1
  v_mul_f32 v160, v105, v105
  v_mul_f32 v161, v104, v105
  v_fma_f32 v164, v104, v104, -v160
  v_add_f32 v165, v161, v161
  s_waitcnt vmcnt(0)
  v_pk_fma_f32 v[28:29], v[164:165], v[30:31], v[28:29] op_sel_hi:[0,1,1]
  v_pk_fma_f32 v[28:29], v[164:165], v[30:31], v[28:29] op_sel:[1,1,0] op_sel_hi:[1,0,1] neg_lo:[1,0,0]
  v_pk_fma_f32 v[26:27], v[164:165], v[28:29], v[26:27] op_sel_hi:[0,1,1]
  v_pk_fma_f32 v[26:27], v[164:165], v[28:29], v[26:27] op_sel:[1,1,0] op_sel_hi:[1,0,1] neg_lo:[1,0,0]
  v_pk_fma_f32 v[24:25], v[164:165], v[26:27], v[24:25] op_sel_hi:[0,1,1]
  v_pk_fma_f32 v[24:25], v[164:165], v[26:27], v[24:25] op_sel:[1,1,0] op_sel_hi:[1,0,1] neg_lo:[1,0,0]
  v_pk_fma_f32 v[22:23], v[164:165], v[24:25], v[22:23] op_sel_hi:[0,1,1]
  v_pk_fma_f32 v[22:23], v[164:165], v[24:25], v[22:23] op_sel:[1,1,0] op_sel_hi:[1,0,1] neg_lo:[1,0,0]
  v_pk_fma_f32 v[20:21], v[164:165], v[22:23], v[20:21] op_sel_hi:[0,1,1]
  v_pk_fma_f32 v[20:21], v[164:165], v[22:23], v[20:21] op_sel:[1,1,0] op_sel_hi:[1,0,1] neg_lo:[1,0,0]
  v_pk_fma_f32 v[18:19], v[164:165], v[20:21], v[18:19] op_sel_hi:[0,1,1]
  v_pk_fma_f32 v[18:19], v[164:165], v[20:21], v[18:19] op_sel:[1,1,0] op_sel_hi:[1,0,1] neg_lo:[1,0,0]
  v_pk_fma_f32 v[16:17], v[164:165], v[18:19], v[16:17] op_sel_hi:[0,1,1]
  v_pk_fma_f32 v[16:17], v[164:165], v[18:19], v[16:17] op_sel:[1,1,0] op_sel_hi:[1,0,1] neg_lo:[1,0,0]
  v_mov_b32 v162, v16
  v_mov_b32 v163, v17
  s_nop 1
  v_permlane32_swap_b32 v16, v162
  v_permlane32_swap_b32 v17, v163
  s_nop 1
  v_pk_fma_f32 v[16:17], v[104:105], v[162:163], v[16:17] op_sel_hi:[0,1,1]
  v_pk_fma_f32 v[16:17], v[104:105], v[162:163], v[16:17] op_sel:[1,1,0] op_sel_hi:[1,0,1] neg_lo:[1,0,0]
  v_pk_fma_f32 v[158:159], v[102:103], v[16:17], v[100:101] op_sel_hi:[0,1,1]
  v_pk_fma_f32 v[158:159], v[102:103], v[16:17], v[158:159] op_sel:[1,1,0] op_sel_hi:[1,0,1] neg_lo:[1,0,0]
  v_pk_fma_f32 v[64:65], v[96:97], v[158:159], v[64:65] op_sel_hi:[0,1,1]
  v_pk_fma_f32 v[64:65], v[96:97], v[158:159], v[64:65] op_sel:[1,1,0] op_sel_hi:[1,0,1] neg_lo:[1,0,0]
  v_pk_fma_f32 v[66:67], v[96:97], v[64:65], v[66:67] op_sel_hi:[0,1,1]
  v_pk_fma_f32 v[66:67], v[96:97], v[64:65], v[66:67] op_sel:[1,1,0] op_sel_hi:[1,0,1] neg_lo:[1,0,0]
  v_pk_fma_f32 v[68:69], v[96:97], v[66:67], v[68:69] op_sel_hi:[0,1,1]
  v_pk_fma_f32 v[68:69], v[96:97], v[66:67], v[68:69] op_sel:[1,1,0] op_sel_hi:[1,0,1] neg_lo:[1,0,0]
  v_pk_fma_f32 v[70:71], v[96:97], v[68:69], v[70:71] op_sel_hi:[0,1,1]
  v_pk_fma_f32 v[70:71], v[96:97], v[68:69], v[70:71] op_sel:[1,1,0] op_sel_hi:[1,0,1] neg_lo:[1,0,0]
  v_pk_fma_f32 v[72:73], v[96:97], v[70:71], v[72:73] op_sel_hi:[0,1,1]
  v_pk_fma_f32 v[72:73], v[96:97], v[70:71], v[72:73] op_sel:[1,1,0] op_sel_hi:[1,0,1] neg_lo:[1,0,0]
  v_pk_fma_f32 v[74:75], v[96:97], v[72:73], v[74:75] op_sel_hi:[0,1,1]
  v_pk_fma_f32 v[74:75], v[96:97], v[72:73], v[74:75] op_sel:[1,1,0] op_sel_hi:[1,0,1] neg_lo:[1,0,0]
  v_pk_fma_f32 v[76:77], v[96:97], v[74:75], v[76:77] op_sel_hi:[0,1,1]
  v_pk_fma_f32 v[76:77], v[96:97], v[74:75], v[76:77] op_sel:[1,1,0] op_sel_hi:[1,0,1] neg_lo:[1,0,0]
  v_pk_fma_f32 v[78:79], v[96:97], v[76:77], v[78:79] op_sel_hi:[0,1,1]
  v_pk_fma_f32 v[78:79], v[96:97], v[76:77], v[78:79] op_sel:[1,1,0] op_sel_hi:[1,0,1] neg_lo:[1,0,0]
  v_pk_fma_f32 v[80:81], v[96:97], v[78:79], v[80:81] op_sel_hi:[0,1,1]
  v_pk_fma_f32 v[80:81], v[96:97], v[78:79], v[80:81] op_sel:[1,1,0] op_sel_hi:[1,0,1] neg_lo:[1,0,0]
  v_pk_fma_f32 v[82:83], v[96:97], v[80:81], v[82:83] op_sel_hi:[0,1,1]
  v_pk_fma_f32 v[82:83], v[96:97], v[80:81], v[82:83] op_sel:[1,1,0] op_sel_hi:[1,0,1] neg_lo:[1,0,0]
  v_pk_fma_f32 v[84:85], v[96:97], v[82:83], v[84:85] op_sel_hi:[0,1,1]
  v_pk_fma_f32 v[84:85], v[96:97], v[82:83], v[84:85] op_sel:[1,1,0] op_sel_hi:[1,0,1] neg_lo:[1,0,0]
  v_pk_fma_f32 v[86:87], v[96:97], v[84:85], v[86:87] op_sel_hi:[0,1,1]
  v_pk_fma_f32 v[86:87], v[96:97], v[84:85], v[86:87] op_sel:[1,1,0] op_sel_hi:[1,0,1] neg_lo:[1,0,0]
  v_pk_fma_f32 v[88:89], v[96:97], v[86:87], v[88:89] op_sel_hi:[0,1,1]
  v_pk_fma_f32 v[88:89], v[96:97], v[86:87], v[88:89] op_sel:[1,1,0] op_sel_hi:[1,0,1] neg_lo:[1,0,0]
  v_pk_fma_f32 v[90:91], v[96:97], v[88:89], v[90:91] op_sel_hi:[0,1,1]
  v_pk_fma_f32 v[90:91], v[96:97], v[88:89], v[90:91] op_sel:[1,1,0] op_sel_hi:[1,0,1] neg_lo:[1,0,0]
  v_pk_fma_f32 v[92:93], v[96:97], v[90:91], v[92:93] op_sel_hi:[0,1,1]
  v_pk_fma_f32 v[92:93], v[96:97], v[90:91], v[92:93] op_sel:[1,1,0] op_sel_hi:[1,0,1] neg_lo:[1,0,0]
  v_pk_fma_f32 v[94:95], v[96:97], v[92:93], v[94:95] op_sel_hi:[0,1,1]
  v_pk_fma_f32 v[94:95], v[96:97], v[92:93], v[94:95] op_sel:[1,1,0] op_sel_hi:[1,0,1] neg_lo:[1,0,0]
  s_lshl_b32 s34, s22, 2
  s_add_u32 s34, s34, s3
  s_mul_i32 s34, s34, 37
  s_add_u32 s34, s34, s29
  s_lshl_b32 s34, s34, 11
  s_add_u32 s34, s34, 11534336
  s_add_u32 s35, s34, 36864
  v_lshrrev_b32 v160, 5, v2
  v_lshlrev_b32 v162, 4, v1
  v_mul_u32_u24 v160, 1152, v160
  v_xor_b32 v162, v162, v160
  v_xor_b32 v163, 576, v162
  s_mov_b32 s30, s46
  v_add_u32 v162, s30, v162
  v_add_u32 v163, s30, v163
  v_cvt_pk_bf16_f32 v32, v64, v66
  v_cvt_pk_bf16_f32 v33, v68, v70
  v_cvt_pk_bf16_f32 v34, v72, v74
  v_cvt_pk_bf16_f32 v35, v76, v78
  ds_write_b128 v162, v[32:35] offset:0
  v_cvt_pk_bf16_f32 v36, v80, v82
  v_cvt_pk_bf16_f32 v37, v84, v86
  v_cvt_pk_bf16_f32 v38, v88, v90
  v_cvt_pk_bf16_f32 v39, v92, v94
  ds_write_b128 v163, v[36:39] offset:0
  v_cvt_pk_bf16_f32 v40, -v65, -v67
  v_cvt_pk_bf16_f32 v41, -v69, -v71
  v_cvt_pk_bf16_f32 v42, -v73, -v75
  v_cvt_pk_bf16_f32 v43, -v77, -v79
  ds_write_b128 v162, v[40:43] offset:2048
  v_cvt_pk_bf16_f32 v44, -v81, -v83
  v_cvt_pk_bf16_f32 v45, -v85, -v87
  v_cvt_pk_bf16_f32 v46, -v89, -v91
  v_cvt_pk_bf16_f32 v47, -v93, -v95
  ds_write_b128 v163, v[44:47] offset:2048
  v_lshrrev_b32 v16, 5, v2
  v_bfe_u32 v17, v2, 2, 2
  v_lshl_add_u32 v17, v16, 3, v17
  v_bfe_u32 v18, v2, 4, 1
  v_bfe_u32 v19, v2, 1, 1
  v_lshl_add_u32 v18, v18, 1, v19
  v_lshlrev_b32 v19, 2, v18
  v_xor_b32 v17, v17, v19
  v_and_b32 v19, 1, v2
  v_lshlrev_b32 v19, 3, v19
  v_lshl_add_u32 v19, v18, 9, v19
  v_add_u32 v19, s30, v19
  v_lshl_add_u32 v16, v17, 4, v19
  v_xor_b32 v17, 64, v16
  ds_read_b64_tr_b16 v[48:49], v16 offset:0
  ds_read_b64_tr_b16 v[50:51], v17 offset:0
  ds_read_b64_tr_b16 v[52:53], v16 offset:256
  ds_read_b64_tr_b16 v[54:55], v17 offset:256
  ds_read_b64_tr_b16 v[56:57], v16 offset:2048
  ds_read_b64_tr_b16 v[58:59], v17 offset:2048
  ds_read_b64_tr_b16 v[60:61], v16 offset:2304
  ds_read_b64_tr_b16 v[62:63], v17 offset:2304
  s_waitcnt lgkmcnt(0)
  buffer_store_dwordx4 v[48:51], v3, s[4:7], s34 offen offset:0 sc0 sc1
  buffer_store_dwordx4 v[52:55], v3, s[4:7], s34 offen offset:1024 sc0 sc1
  buffer_store_dwordx4 v[56:59], v3, s[4:7], s35 offen offset:0 sc0 sc1
  buffer_store_dwordx4 v[60:63], v3, s[4:7], s35 offen offset:1024 sc0 sc1
  s_mul_i32 s30, s22, 24
  s_add_u32 s31, s30, s29
  s_lshl_b32 s31, s31, 2
  s_add_u32 s31, s31, s3
  s_lshl_b32 s31, s31, 2
  s_add_u32 s31, s31, 17828864
  s_waitcnt vmcnt(0)
  v_mov_b32 v160, 0
  v_mov_b32 v161, 1
  s_mov_b64 exec, 1
  buffer_store_dword v161, v160, s[4:7], s31 offen sc0 sc1
  s_mov_b64 exec, -1
  s_cmp_lg_u32 s24, 2
  s_cbranch_scc1 L_p2end
  s_cmp_eq_u32 s29, s26
  s_cbranch_scc1 L_p2end
  v_pk_mov_b32 v[64:65], v[108:109], v[108:109] op_sel:[0,1]
  v_pk_mov_b32 v[66:67], v[110:111], v[110:111] op_sel:[0,1]
  v_pk_mov_b32 v[68:69], v[112:113], v[112:113] op_sel:[0,1]
  v_pk_mov_b32 v[70:71], v[114:115], v[114:115] op_sel:[0,1]
  v_pk_mov_b32 v[72:73], v[116:117], v[116:117] op_sel:[0,1]
  v_pk_mov_b32 v[74:75], v[118:119], v[118:119] op_sel:[0,1]
  v_pk_mov_b32 v[76:77], v[120:121], v[120:121] op_sel:[0,1]
  v_pk_mov_b32 v[78:79], v[122:123], v[122:123] op_sel:[0,1]
  v_pk_mov_b32 v[80:81], v[124:125], v[124:125] op_sel:[0,1]
  v_pk_mov_b32 v[82:83], v[126:127], v[126:127] op_sel:[0,1]
  v_pk_mov_b32 v[84:85], v[128:129], v[128:129] op_sel:[0,1]
  v_pk_mov_b32 v[86:87], v[130:131], v[130:131] op_sel:[0,1]
  v_pk_mov_b32 v[88:89], v[132:133], v[132:133] op_sel:[0,1]
  v_pk_mov_b32 v[90:91], v[134:135], v[134:135] op_sel:[0,1]
  v_pk_mov_b32 v[92:93], v[136:137], v[136:137] op_sel:[0,1]
  v_pk_mov_b32 v[94:95], v[138:139], v[138:139] op_sel:[0,1]
  v_pk_mov_b32 v[96:97], v[140:141], v[140:141] op_sel:[0,1]
  v_pk_mov_b32 v[98:99], v[142:143], v[142:143] op_sel:[0,1]
  v_pk_mov_b32 v[100:101], v[144:145], v[144:145] op_sel:[0,1]
  v_pk_mov_b32 v[102:103], v[146:147], v[146:147] op_sel:[0,1]
  v_pk_mov_b32 v[104:105], v[148:149], v[148:149] op_sel:[0,1]
  s_mov_b32 s29, s26
  s_branch L_p2
L_p2end:
  s_mov_b64 exec, 1
  ds_add_u32 v156, v157 offset:16
  s_mov_b64 exec, -1
  s_lshl_b32 s37, s20, 1
  s_and_b32 s30, s21, 1
  s_add_u32 s37, s37, s30
  s_lshr_b32 s38, s21, 1
  s_lshl_b32 s57, s37, 2
  s_add_u32 s57, s57, s51
  s_mov_b32 s16, s88
  s_and_b32 s17, s89, 0xffff
  s_mov_b32 s18, 9437184
  s_mov_b32 s19, 0x20000
  s_cmp_ge_u32 s21, 18
  s_cbranch_scc1 L_a3
  s_mov_b64 exec, 0
  s_branch PB3_0
PB3_ret:
  s_mov_b64 exec, -1
  s_mov_b32 s16, s88
  s_and_b32 s17, s89, 0xffff
  s_mov_b32 s18, 9437184
  s_mov_b32 s19, 0x20000
  v_lshrrev_b32 v159, 5, v2
  v_bfe_u32 v160, v1, 1, 3
  v_xor_b32 v160, v160, v159
  v_lshlrev_b32 v161, 7, v1
  v_add_u32 v161, 100352, v161
  v_xor_b32 v162, 0, v160
  v_lshl_add_u32 v4, v162, 4, v161
  v_xor_b32 v162, 2, v160
  v_lshl_add_u32 v5, v162, 4, v161
  v_xor_b32 v162, 4, v160
  v_lshl_add_u32 v6, v162, 4, v161
  v_xor_b32 v162, 6, v160
  v_lshl_add_u32 v7, v162, 4, v161
  v_add_u32 v8, 4294924288, v4
  v_add_u32 v9, 4294924288, v5
  v_add_u32 v10, 4294924288, v6
  v_add_u32 v11, 4294924288, v7
  s_mov_b32 s49, 0
  s_mul_i32 s34, s37, 384
  s_lshl_b32 s30, s51, 2
  s_add_u32 s34, s34, s30
  s_add_u32 s34, s34, 17828864
  v_min_u32 v158, 17, v2
  v_lshlrev_b32 v158, 4, v158
  s_mov_b32 s33, 0
L_pollF30:
  buffer_load_dword v159, v158, s[4:7], s34 offen sc0 sc1
  s_waitcnt vmcnt(0)
  v_cmp_ne_u32 vcc, 1, v159
  s_add_u32 s33, s33, 1
  s_cmp_gt_u32 s33, 20000
  s_cbranch_scc1 L_pollF30_x
  s_cbranch_vccz L_pollF30_x
  s_sleep 16
  s_branch L_pollF30
L_pollF30_x:
  s_mul_i32 s50, s57, 75776
  s_add_u32 s50, s50, 11534336
  s_lshl_b32 s31, s38, 11
  s_add_u32 s30, s50, s31
  s_add_u32 s30, s30, 18432
  buffer_load_dwordx4 v[48:51], v3, s[4:7], s50 offen offset:0 sc0 sc1
  buffer_load_dwordx4 v[52:55], v3, s[4:7], s50 offen offset:1024 sc0 sc1
  buffer_load_dwordx4 v[56:59], v3, s[4:7], s50 offen offset:2048 sc0 sc1
  buffer_load_dwordx4 v[60:63], v3, s[4:7], s50 offen offset:3072 sc0 sc1
  s_add_u32 s50, s50, 4096
  buffer_load_dwordx4 v[64:67], v3, s[4:7], s50 offen offset:0 sc0 sc1
  buffer_load_dwordx4 v[68:71], v3, s[4:7], s50 offen offset:1024 sc0 sc1
  buffer_load_dwordx4 v[72:75], v3, s[4:7], s50 offen offset:2048 sc0 sc1
  buffer_load_dwordx4 v[76:79], v3, s[4:7], s50 offen offset:3072 sc0 sc1
  s_add_u32 s50, s50, 4096
  buffer_load_dwordx4 v[80:83], v3, s[4:7], s50 offen offset:0 sc0 sc1
  buffer_load_dwordx4 v[84:87], v3, s[4:7], s50 offen offset:1024 sc0 sc1
  buffer_load_dwordx4 v[88:91], v3, s[4:7], s50 offen offset:2048 sc0 sc1
  buffer_load_dwordx4 v[92:95], v3, s[4:7], s50 offen offset:3072 sc0 sc1
  s_add_u32 s50, s50, 4096
  buffer_load_dwordx4 v[96:99], v3, s[4:7], s50 offen offset:0 sc0 sc1
  buffer_load_dwordx4 v[100:103], v3, s[4:7], s50 offen offset:1024 sc0 sc1
  buffer_load_dwordx4 v[104:107], v3, s[4:7], s50 offen offset:2048 sc0 sc1
  buffer_load_dwordx4 v[108:111], v3, s[4:7], s50 offen offset:3072 sc0 sc1
  s_add_u32 s50, s50, 4096
  buffer_load_dwordx4 v[112:115], v3, s[4:7], s50 offen offset:0 sc0 sc1
  buffer_load_dwordx4 v[116:119], v3, s[4:7], s50 offen offset:1024 sc0 sc1
  s_mov_b32 s34, 4
  v_and_b32 v158, 3, v2
  v_lshlrev_b32 v158, 2, v158
  v_add_u32 v158, 159808, v158
  s_mov_b32 s33, 0
  s_mov_b32 s30, 1342177280
L_pg_43:
  ds_read_b32 v159, v158
  s_add_u32 s33, s33, 1
  s_waitcnt lgkmcnt(0)
  v_cmp_gt_u32 vcc, 159772, v159
  s_cmp_gt_u32 s33, 160000
  s_cbranch_scc1 L_pg_43x
  s_cbranch_vccz L_pg_43x
  s_sleep 32
  s_branch L_pg_43
L_pg_43x:
  v_and_b32 v158, 3, v2
  v_lshlrev_b32 v158, 2, v158
  v_add_u32 v158, 159808, v158
  s_mov_b32 s33, 0
  s_mov_b32 s30, 1342177280
L_pg_44:
  ds_read_b32 v159, v158
  s_add_u32 s33, s33, 1
  s_waitcnt lgkmcnt(0)
  v_cmp_gt_u32 vcc, 1073741824, v159
  s_cmp_gt_u32 s33, 160000
  s_cbranch_scc1 L_pg_44x
  s_cbranch_vccz L_pg_44x
  s_sleep 3
  s_branch L_pg_44
L_pg_44x:
  v_cmp_eq_u32 vcc, s30, v159
  s_cbranch_vccz L_af_42
  s_barrier
  s_barrier
  s_barrier
  s_mov_b32 s34, 8
L_af_42:
  s_setprio 3
L_b3main:
  s_mov_b32 s33, 0
L_sp_45:
  ds_read_b32 v158, v156 offset:20
  s_add_u32 s33, s33, 1
  s_waitcnt lgkmcnt(0)
  v_readfirstlane_b32 s32, v158
  s_cmp_ge_u32 s32, s34
  s_cbranch_scc1 L_sp_45x
  s_cmp_lt_u32 s33, 320000
  s_cbranch_scc1 L_sp_45
L_sp_45x:
PB3_0:
  s_cbranch_execz PB3_1
  ds_read_b128 v[16:19], v4 offset:0
  ds_read_b128 v[20:23], v4 offset:4096
  ds_read_b128 v[24:27], v5 offset:0
  ds_read_b128 v[28:31], v5 offset:4096
  ds_read_b128 v[32:35], v6 offset:0
  ds_read_b128 v[36:39], v6 offset:4096
  s_waitcnt vmcnt(17) lgkmcnt(4)
PB3_1:
  s_cbranch_execz PB3_2
  v_mfma_f32_32x32x16_bf16 v[120:135], v[16:19], v[48:51], 0
  ds_read_b128 v[40:43], v7 offset:0
  ds_read_b128 v[44:47], v7 offset:4096
  v_mfma_f32_32x32x16_bf16 v[136:151], v[20:23], v[48:51], 0
  buffer_load_dwordx4 v[48:51], v3, s[4:7], s50 offen offset:2048 sc0 sc1
  s_waitcnt vmcnt(17) lgkmcnt(4)
  v_mfma_f32_32x32x16_bf16 v[120:135], v[24:27], v[52:55], v[120:135]
PB3_2:
  s_cbranch_execz PB3_3
  ds_read_b128 v[16:19], v4 offset:8192
  ds_read_b128 v[20:23], v4 offset:12288
  v_mfma_f32_32x32x16_bf16 v[136:151], v[28:31], v[52:55], v[136:151]
  buffer_load_dwordx4 v[52:55], v3, s[4:7], s50 offen offset:3072 sc0 sc1
  s_add_u32 s50, s50, 4096
  s_waitcnt vmcnt(17) lgkmcnt(4)
  v_mfma_f32_32x32x16_bf16 v[120:135], v[32:35], v[56:59], v[120:135]
PB3_3:
  s_cbranch_execz PB3_4
  ds_read_b128 v[24:27], v5 offset:8192
  ds_read_b128 v[28:31], v5 offset:12288
  v_mfma_f32_32x32x16_bf16 v[136:151], v[36:39], v[56:59], v[136:151]
  buffer_load_dwordx4 v[56:59], v3, s[4:7], s50 offen offset:0 sc0 sc1
  s_waitcnt vmcnt(17) lgkmcnt(4)
  v_mfma_f32_32x32x16_bf16 v[120:135], v[40:43], v[60:63], v[120:135]
  ds_read_b128 v[32:35], v6 offset:8192
PB3_4:
  s_cbranch_execz PB3_5
  ds_read_b128 v[36:39], v6 offset:12288
  v_mfma_f32_32x32x16_bf16 v[136:151], v[44:47], v[60:63], v[136:151]
  buffer_load_dwordx4 v[60:63], v3, s[4:7], s50 offen offset:1024 sc0 sc1
  s_waitcnt vmcnt(17) lgkmcnt(4)
  v_mfma_f32_32x32x16_bf16 v[120:135], v[16:19], v[64:67], v[120:135]
  ds_read_b128 v[40:43], v7 offset:8192
  ds_read_b128 v[44:47], v7 offset:12288
PB3_5:
  s_cbranch_execz PB3_6
  v_mfma_f32_32x32x16_bf16 v[136:151], v[20:23], v[64:67], v[136:151]
  buffer_load_dwordx4 v[64:67], v3, s[4:7], s50 offen offset:2048 sc0 sc1
  s_waitcnt vmcnt(17) lgkmcnt(4)
  v_mfma_f32_32x32x16_bf16 v[120:135], v[24:27], v[68:71], v[120:135]
  ds_read_b128 v[16:19], v4 offset:16384
  ds_read_b128 v[20:23], v4 offset:20480
  v_mfma_f32_32x32x16_bf16 v[136:151], v[28:31], v[68:71], v[136:151]
PB3_6:
  s_cbranch_execz PB3_7
  buffer_load_dwordx4 v[68:71], v3, s[4:7], s50 offen offset:3072 sc0 sc1
  s_add_u32 s50, s50, 4096
  s_waitcnt vmcnt(17) lgkmcnt(4)
  v_mfma_f32_32x32x16_bf16 v[120:135], v[32:35], v[72:75], v[120:135]
  ds_read_b128 v[24:27], v5 offset:16384
  ds_read_b128 v[28:31], v5 offset:20480
  v_mfma_f32_32x32x16_bf16 v[136:151], v[36:39], v[72:75], v[136:151]
PB3_7:
  s_cbranch_execz PB3_8
  buffer_load_dwordx4 v[72:75], v3, s[4:7], s50 offen offset:0 sc0 sc1
  s_waitcnt vmcnt(17) lgkmcnt(4)
  v_mfma_f32_32x32x16_bf16 v[120:135], v[40:43], v[76:79], v[120:135]
  ds_read_b128 v[32:35], v6 offset:16384
  ds_read_b128 v[36:39], v6 offset:20480
  v_mfma_f32_32x32x16_bf16 v[136:151], v[44:47], v[76:79], v[136:151]
  buffer_load_dwordx4 v[76:79], v3, s[4:7], s50 offen offset:1024 sc0 sc1
PB3_8:
  s_cbranch_execz PB3_9
  s_waitcnt vmcnt(17) lgkmcnt(4)
  v_mfma_f32_32x32x16_bf16 v[120:135], v[16:19], v[80:83], v[120:135]
  ds_read_b128 v[40:43], v7 offset:16384
  ds_read_b128 v[44:47], v7 offset:20480
  v_mfma_f32_32x32x16_bf16 v[136:151], v[20:23], v[80:83], v[136:151]
  buffer_load_dwordx4 v[80:83], v3, s[4:7], s50 offen offset:2048 sc0 sc1
  s_setprio 2
PB3_9:
  s_cbranch_execz PB3_10
  s_waitcnt vmcnt(17) lgkmcnt(4)
  v_mfma_f32_32x32x16_bf16 v[120:135], v[24:27], v[84:87], v[120:135]
  ds_read_b128 v[16:19], v4 offset:24576
  ds_read_b128 v[20:23], v4 offset:28672
  v_mfma_f32_32x32x16_bf16 v[136:151], v[28:31], v[84:87], v[136:151]
  buffer_load_dwordx4 v[84:87], v3, s[4:7], s50 offen offset:3072 sc0 sc1
  s_add_u32 s50, s50, 4096
PB3_10:
  s_cbranch_execz PB3_11
  s_waitcnt vmcnt(17) lgkmcnt(4)
  v_mfma_f32_32x32x16_bf16 v[120:135], v[32:35], v[88:91], v[120:135]
  ds_read_b128 v[24:27], v5 offset:24576
  ds_read_b128 v[28:31], v5 offset:28672
  v_mfma_f32_32x32x16_bf16 v[136:151], v[36:39], v[88:91], v[136:151]
  buffer_load_dwordx4 v[88:91], v3, s[4:7], s50 offen offset:0 sc0 sc1
  s_waitcnt vmcnt(17) lgkmcnt(4)
PB3_11:
  s_cbranch_execz PB3_12
  v_mfma_f32_32x32x16_bf16 v[120:135], v[40:43], v[92:95], v[120:135]
  ds_read_b128 v[32:35], v6 offset:24576
  ds_read_b128 v[36:39], v6 offset:28672
  v_mfma_f32_32x32x16_bf16 v[136:151], v[44:47], v[92:95], v[136:151]
  buffer_load_dwordx4 v[92:95], v3, s[4:7], s50 offen offset:1024 sc0 sc1
  s_cmp_eq_u32 s49, 0
  s_cbranch_scc1 L_b3g
  s_waitcnt vmcnt(12)
PB3_12:
  s_cbranch_execz PB3_13
  s_mov_b64 exec, 1
  ds_add_u32 v156, v157 offset:24
  s_mov_b64 exec, -1
  s_waitcnt lgkmcnt(0)
L_b3g:
  s_waitcnt vmcnt(17) lgkmcnt(4)
  v_mfma_f32_32x32x16_bf16 v[120:135], v[16:19], v[96:99], v[120:135]
  ds_read_b128 v[40:43], v7 offset:24576
PB3_13:
  s_cbranch_execz PB3_14
  ds_read_b128 v[44:47], v7 offset:28672
  v_mfma_f32_32x32x16_bf16 v[136:151], v[20:23], v[96:99], v[136:151]
  buffer_load_dwordx4 v[96:99], v3, s[4:7], s50 offen offset:2048 sc0 sc1
  s_waitcnt vmcnt(17) lgkmcnt(4)
  v_mfma_f32_32x32x16_bf16 v[120:135], v[24:27], v[100:103], v[120:135]
  ds_read_b128 v[16:19], v4 offset:32768
  ds_read_b128 v[20:23], v4 offset:36864
PB3_14:
  s_cbranch_execz PB3_15
  v_mfma_f32_32x32x16_bf16 v[136:151], v[28:31], v[100:103], v[136:151]
  buffer_load_dwordx4 v[100:103], v3, s[4:7], s50 offen offset:3072 sc0 sc1
  s_add_u32 s50, s50, 4096
  s_waitcnt vmcnt(17) lgkmcnt(4)
  v_mfma_f32_32x32x16_bf16 v[120:135], v[32:35], v[104:107], v[120:135]
  ds_read_b128 v[24:27], v5 offset:32768
  ds_read_b128 v[28:31], v5 offset:36864
PB3_15:
  s_cbranch_execz PB3_16
  v_mfma_f32_32x32x16_bf16 v[136:151], v[36:39], v[104:107], v[136:151]
  buffer_load_dwordx4 v[104:107], v3, s[4:7], s50 offen offset:0 sc0 sc1
  s_waitcnt vmcnt(17) lgkmcnt(4)
  v_mfma_f32_32x32x16_bf16 v[120:135], v[40:43], v[108:111], v[120:135]
  ds_read_b128 v[32:35], v6 offset:32768
  ds_read_b128 v[36:39], v6 offset:36864
  v_mfma_f32_32x32x16_bf16 v[136:151], v[44:47], v[108:111], v[136:151]
PB3_16:
  s_cbranch_execz PB3_17
  buffer_load_dwordx4 v[108:111], v3, s[4:7], s50 offen offset:1024 sc0 sc1
  s_waitcnt vmcnt(17) lgkmcnt(4)
  v_mfma_f32_32x32x16_bf16 v[120:135], v[16:19], v[112:115], v[120:135]
  ds_read_b128 v[40:43], v7 offset:32768
  ds_read_b128 v[44:47], v7 offset:36864
  v_mfma_f32_32x32x16_bf16 v[136:151], v[20:23], v[112:115], v[136:151]
  buffer_load_dwordx4 v[112:115], v3, s[4:7], s50 offen offset:2048 sc0 sc1
PB3_17:
  s_cbranch_execz PB3_18
  s_waitcnt vmcnt(17) lgkmcnt(4)
  v_mfma_f32_32x32x16_bf16 v[120:135], v[24:27], v[116:119], v[120:135]
  ds_read_b128 v[16:19], v4 offset:40960
  ds_read_b128 v[20:23], v4 offset:45056
  v_mfma_f32_32x32x16_bf16 v[136:151], v[28:31], v[116:119], v[136:151]
  buffer_load_dwordx4 v[116:119], v3, s[4:7], s50 offen offset:3072 sc0 sc1
  s_add_u32 s50, s50, 4096
PB3_18:
  s_cbranch_execz PB3_19
  s_setprio 1
  s_waitcnt vmcnt(17) lgkmcnt(4)
  v_mfma_f32_32x32x16_bf16 v[120:135], v[32:35], v[48:51], v[120:135]
  ds_read_b128 v[24:27], v5 offset:40960
  ds_read_b128 v[28:31], v5 offset:45056
  v_mfma_f32_32x32x16_bf16 v[136:151], v[36:39], v[48:51], v[136:151]
  s_waitcnt vmcnt(16) lgkmcnt(4)
PB3_19:
  s_cbranch_execz PB3_20
  v_mfma_f32_32x32x16_bf16 v[120:135], v[40:43], v[52:55], v[120:135]
  ds_read_b128 v[32:35], v6 offset:40960
  ds_read_b128 v[36:39], v6 offset:45056
  v_mfma_f32_32x32x16_bf16 v[136:151], v[44:47], v[52:55], v[136:151]
  s_waitcnt vmcnt(15) lgkmcnt(4)
  v_mfma_f32_32x32x16_bf16 v[120:135], v[16:19], v[56:59], v[120:135]
  ds_read_b128 v[40:43], v7 offset:40960
PB3_20:
  s_cbranch_execz PB3_21
  ds_read_b128 v[44:47], v7 offset:45056
  v_mfma_f32_32x32x16_bf16 v[136:151], v[20:23], v[56:59], v[136:151]
  s_waitcnt vmcnt(14) lgkmcnt(4)
  v_mfma_f32_32x32x16_bf16 v[120:135], v[24:27], v[60:63], v[120:135]
  ds_read_b128 v[16:19], v4 offset:49152
  ds_read_b128 v[20:23], v4 offset:53248
  v_mfma_f32_32x32x16_bf16 v[136:151], v[28:31], v[60:63], v[136:151]
PB3_21:
  s_cbranch_execz PB3_22
  v_lshrrev_b32 v160, 4, v2
  v_and_b32 v161, 15, v2
  v_mul_u32_u24 v162, 1152, v160
  v_lshl_add_u32 v162, v161, 3, v162
  s_lshl_b32 s31, s38, 7
  v_lshl_add_u32 v163, v161, 3, s31
  global_load_dwordx2 v[56:57], v163, s[86:87]
PB3_22:
  s_cbranch_execz PB3_23
  s_lshl_b32 s30, s57, 1
  s_add_u32 s30, s30, s49
  s_mul_i32 s30, s30, 18432
  s_add_u32 s30, s30, s31
  s_mov_b32 s8, s70
  s_and_b32 s9, s71, 0xffff
  s_mov_b32 s10, 2359296
PB3_23:
  s_cbranch_execz PB3_24
  s_mov_b32 s11, 0x20000
  buffer_load_dwordx2 v[48:49], v162, s[8:11], s30 offen
  s_add_u32 s30, s30, 4608
  buffer_load_dwordx2 v[50:51], v162, s[8:11], s30 offen
  s_add_u32 s30, s30, 4608
  buffer_load_dwordx2 v[52:53], v162, s[8:11], s30 offen
  s_add_u32 s30, s30, 4608
PB3_24:
  s_cbranch_execz PB3_25
  buffer_load_dwordx2 v[54:55], v162, s[8:11], s30 offen
  s_add_u32 s30, s30, 4608
  s_waitcnt vmcnt(18) lgkmcnt(4)
  v_mfma_f32_32x32x16_bf16 v[120:135], v[32:35], v[64:67], v[120:135]
  ds_read_b128 v[24:27], v5 offset:49152
  ds_read_b128 v[28:31], v5 offset:53248
  v_mfma_f32_32x32x16_bf16 v[136:151], v[36:39], v[64:67], v[136:151]
PB3_25:
  s_cbranch_execz PB3_26
  s_waitcnt vmcnt(17) lgkmcnt(4)
  v_mfma_f32_32x32x16_bf16 v[120:135], v[40:43], v[68:71], v[120:135]
  ds_read_b128 v[32:35], v6 offset:49152
  ds_read_b128 v[36:39], v6 offset:53248
  v_mfma_f32_32x32x16_bf16 v[136:151], v[44:47], v[68:71], v[136:151]
  s_mov_b64 exec, 1
  ds_add_u32 v156, v157 offset:32
PB3_26:
  s_cbranch_execz PB3_27
  s_mov_b64 exec, -1
  s_waitcnt lgkmcnt(0)
  s_waitcnt vmcnt(16) lgkmcnt(4)
  v_mfma_f32_32x32x16_bf16 v[120:135], v[16:19], v[72:75], v[120:135]
  ds_read_b128 v[40:43], v7 offset:49152
  ds_read_b128 v[44:47], v7 offset:53248
  v_mfma_f32_32x32x16_bf16 v[136:151], v[20:23], v[72:75], v[136:151]
PB3_27:
  s_cbranch_execz PB3_28
  s_lshl_b32 s31, s49, 2
  s_mov_b32 s33, 0
L_sp_46:
  ds_read_b32 v158, v156 offset:24
  s_add_u32 s33, s33, 1
  s_waitcnt lgkmcnt(0)
  v_readfirstlane_b32 s32, v158
  s_cmp_ge_u32 s32, s31
PB3_28:
  s_cbranch_execz PB3_29
  s_cbranch_scc1 L_sp_46x
  s_cmp_lt_u32 s33, 320000
  s_cbranch_scc1 L_sp_46
L_sp_46x:
  s_waitcnt vmcnt(15) lgkmcnt(4)
  v_mfma_f32_32x32x16_bf16 v[120:135], v[24:27], v[76:79], v[120:135]
  ds_read_b128 v[16:19], v8 offset:0
  ds_read_b128 v[20:23], v8 offset:4096
PB3_29:
  s_cbranch_execz PB3_30
  v_mfma_f32_32x32x16_bf16 v[136:151], v[28:31], v[76:79], v[136:151]
  s_waitcnt vmcnt(14) lgkmcnt(4)
  v_mfma_f32_32x32x16_bf16 v[120:135], v[32:35], v[80:83], v[120:135]
  ds_read_b128 v[24:27], v9 offset:0
  ds_read_b128 v[28:31], v9 offset:4096
  v_mfma_f32_32x32x16_bf16 v[136:151], v[36:39], v[80:83], v[136:151]
  s_setprio 0
PB3_30:
  s_cbranch_execz PB3_31
  s_waitcnt vmcnt(13) lgkmcnt(4)
  v_mfma_f32_32x32x16_bf16 v[120:135], v[40:43], v[84:87], v[120:135]
  ds_read_b128 v[32:35], v10 offset:0
  ds_read_b128 v[36:39], v10 offset:4096
  v_mfma_f32_32x32x16_bf16 v[136:151], v[44:47], v[84:87], v[136:151]
  s_waitcnt vmcnt(12) lgkmcnt(4)
  v_mfma_f32_32x32x16_bf16 v[120:135], v[16:19], v[88:91], v[120:135]
PB3_31:
  s_cbranch_execz PB3_32
  ds_read_b128 v[40:43], v11 offset:0
  ds_read_b128 v[44:47], v11 offset:4096
  v_mfma_f32_32x32x16_bf16 v[136:151], v[20:23], v[88:91], v[136:151]
  s_waitcnt vmcnt(11) lgkmcnt(4)
  v_mfma_f32_32x32x16_bf16 v[120:135], v[24:27], v[92:95], v[120:135]
  ds_read_b128 v[16:19], v8 offset:8192
  ds_read_b128 v[20:23], v8 offset:12288
PB3_32:
  s_cbranch_execz PB3_33
  v_mfma_f32_32x32x16_bf16 v[136:151], v[28:31], v[92:95], v[136:151]
  s_waitcnt vmcnt(10) lgkmcnt(4)
  v_mfma_f32_32x32x16_bf16 v[120:135], v[32:35], v[96:99], v[120:135]
  ds_read_b128 v[24:27], v9 offset:8192
  ds_read_b128 v[28:31], v9 offset:12288
  v_mfma_f32_32x32x16_bf16 v[136:151], v[36:39], v[96:99], v[136:151]
  s_waitcnt vmcnt(9) lgkmcnt(4)
PB3_33:
  s_cbranch_execz PB3_34
  v_mfma_f32_32x32x16_bf16 v[120:135], v[40:43], v[100:103], v[120:135]
  ds_read_b128 v[32:35], v10 offset:8192
  ds_read_b128 v[36:39], v10 offset:12288
  v_mfma_f32_32x32x16_bf16 v[136:151], v[44:47], v[100:103], v[136:151]
  s_waitcnt vmcnt(8) lgkmcnt(4)
  v_mfma_f32_32x32x16_bf16 v[120:135], v[16:19], v[104:107], v[120:135]
  ds_read_b128 v[40:43], v11 offset:8192
PB3_34:
  s_cbranch_execz PB3_35
  ds_read_b128 v[44:47], v11 offset:12288
  v_mfma_f32_32x32x16_bf16 v[136:151], v[20:23], v[104:107], v[136:151]
  s_waitcnt vmcnt(7) lgkmcnt(4)
  v_mfma_f32_32x32x16_bf16 v[120:135], v[24:27], v[108:111], v[120:135]
  v_mfma_f32_32x32x16_bf16 v[136:151], v[28:31], v[108:111], v[136:151]
  s_waitcnt vmcnt(6) lgkmcnt(2)
  v_mfma_f32_32x32x16_bf16 v[120:135], v[32:35], v[112:115], v[120:135]
PB3_35:
  s_cbranch_execz PB3_36
  v_mfma_f32_32x32x16_bf16 v[136:151], v[36:39], v[112:115], v[136:151]
  s_waitcnt vmcnt(5) lgkmcnt(0)
  v_mfma_f32_32x32x16_bf16 v[120:135], v[40:43], v[116:119], v[120:135]
  v_mfma_f32_32x32x16_bf16 v[136:151], v[44:47], v[116:119], v[136:151]
  s_mul_i32 s31, s51, 8704
  s_cmp_eq_u32 s49, 0
  s_cselect_b32 s30, 100352, 0
PB3_36:
  s_cbranch_execz PB3_37
  s_add_u32 s30, s30, s31
  v_lshrrev_b32 v159, 5, v2
  v_mul_u32_u24 v164, 272, v1
  v_lshl_add_u32 v164, v159, 4, v164
  v_add_u32 v164, s30, v164
  s_mul_i32 s30, s49, 4352
  s_add_u32 s31, s31, s30
PB3_37:
  s_cbranch_execz PB3_38
  v_mul_u32_u24 v159, 272, v160
  v_lshl_add_u32 v159, v161, 4, v159
  v_add_u32 v159, s31, v159
  v_add_u32 v162, 100352, v159
  v_mul_u32_u24 v155, 4608, v160
  v_lshl_add_u32 v155, v161, 4, v155
  s_mov_b32 s33, 0
PB3_38:
  s_cbranch_execz PB3_39
L_sp_47:
  ds_read_b32 v158, v156 offset:32
  s_add_u32 s33, s33, 1
  s_waitcnt lgkmcnt(0)
  v_readfirstlane_b32 s32, v158
  s_cmp_ge_u32 s32, 8
  s_cbranch_scc1 L_sp_47x
  s_cmp_lt_u32 s33, 320000
PB3_39:
  s_cbranch_execz PB3_40
  s_cbranch_scc1 L_sp_47
L_sp_47x:
  ds_write_b128 v164, v[120:123] offset:0
  ds_write_b128 v164, v[124:127] offset:32
  ds_write_b128 v164, v[128:131] offset:64
  ds_write_b128 v164, v[132:135] offset:96
  ds_write_b128 v164, v[136:139] offset:128
  ds_write_b128 v164, v[140:143] offset:160
PB3_40:
  s_cbranch_execz PB3_41
  ds_write_b128 v164, v[144:147] offset:192
  ds_write_b128 v164, v[148:151] offset:224
  s_mov_b64 exec, 1
  ds_add_u32 v156, v157 offset:32
  s_mov_b64 exec, -1
  s_lshl_b32 s30, s57, 1
  s_add_u32 s30, s30, s49
PB3_41:
  s_cbranch_execz PB3_42
  s_mul_i32 s30, s30, 73728
  s_lshl_b32 s31, s38, 8
  s_add_u32 s30, s30, s31
  s_add_u32 s30, s30, 2304
  s_waitcnt vmcnt(0)
  v_lshlrev_b32 v60, 16, v56
  v_and_b32 v61, 0xffff0000, v56
PB3_42:
  s_cbranch_execz PB3_43
  v_lshlrev_b32 v62, 16, v57
  v_and_b32 v63, 0xffff0000, v57
  v_lshlrev_b32 v64, 16, v48
  v_and_b32 v65, 0xffff0000, v48
  v_lshlrev_b32 v66, 16, v49
  v_and_b32 v67, 0xffff0000, v49
  v_lshlrev_b32 v68, 16, v50
PB3_43:
  s_cbranch_execz PB3_44
  v_and_b32 v69, 0xffff0000, v50
  v_lshlrev_b32 v70, 16, v51
  v_and_b32 v71, 0xffff0000, v51
  v_lshlrev_b32 v72, 16, v52
  v_and_b32 v73, 0xffff0000, v52
  v_lshlrev_b32 v74, 16, v53
  v_and_b32 v75, 0xffff0000, v53
PB3_44:
  s_cbranch_execz PB3_45
  v_lshlrev_b32 v76, 16, v54
  v_and_b32 v77, 0xffff0000, v54
  v_lshlrev_b32 v78, 16, v55
  v_and_b32 v79, 0xffff0000, v55
  s_mov_b32 s33, 0
L_sp_48:
  ds_read_b32 v158, v156 offset:32
  s_add_u32 s33, s33, 1
PB3_45:
  s_cbranch_execz PB3_46
  s_waitcnt lgkmcnt(0)
  v_readfirstlane_b32 s32, v158
  s_cmp_ge_u32 s32, 16
  s_cbranch_scc1 L_sp_48x
  s_cmp_lt_u32 s33, 320000
  s_cbranch_scc1 L_sp_48
L_sp_48x:
  ds_read_b128 v[16:19], v159 offset:0
PB3_46:
  s_cbranch_execz PB3_47
  ds_read_b128 v[20:23], v162 offset:0
  ds_read_b128 v[24:27], v159 offset:1088
  ds_read_b128 v[28:31], v162 offset:1088
  ds_read_b128 v[32:35], v159 offset:2176
  ds_read_b128 v[36:39], v162 offset:2176
  ds_read_b128 v[40:43], v159 offset:3264
  ds_read_b128 v[44:47], v162 offset:3264
PB3_47:
  s_cbranch_execz PB3_48
  s_waitcnt lgkmcnt(6)
  v_pk_fma_f32 v[16:17], v[64:65], v[60:61], v[16:17]
  v_pk_fma_f32 v[18:19], v[66:67], v[62:63], v[18:19]
  v_pk_add_f32 v[16:17], v[16:17], v[20:21]
  v_pk_add_f32 v[18:19], v[18:19], v[22:23]
  buffer_store_dwordx4 v[16:19], v155, s[16:19], s30 offen sc0 sc1
  s_add_u32 s30, s30, 18432
PB3_48:
  s_cbranch_execz PB3_49
  s_waitcnt lgkmcnt(4)
  v_pk_fma_f32 v[24:25], v[68:69], v[60:61], v[24:25]
  v_pk_fma_f32 v[26:27], v[70:71], v[62:63], v[26:27]
  v_pk_add_f32 v[24:25], v[24:25], v[28:29]
  v_pk_add_f32 v[26:27], v[26:27], v[30:31]
  buffer_store_dwordx4 v[24:27], v155, s[16:19], s30 offen sc0 sc1
  s_add_u32 s30, s30, 18432
PB3_49:
  s_cbranch_execz PB3_50
  s_waitcnt lgkmcnt(2)
  v_pk_fma_f32 v[32:33], v[72:73], v[60:61], v[32:33]
  v_pk_fma_f32 v[34:35], v[74:75], v[62:63], v[34:35]
  v_pk_add_f32 v[32:33], v[32:33], v[36:37]
  v_pk_add_f32 v[34:35], v[34:35], v[38:39]
  buffer_store_dwordx4 v[32:35], v155, s[16:19], s30 offen sc0 sc1
  s_add_u32 s30, s30, 18432
PB3_50:
  s_cbranch_execz PB3_51
  s_waitcnt lgkmcnt(0)
  v_pk_fma_f32 v[40:41], v[76:77], v[60:61], v[40:41]
  v_pk_fma_f32 v[42:43], v[78:79], v[62:63], v[42:43]
  v_pk_add_f32 v[40:41], v[40:41], v[44:45]
  v_pk_add_f32 v[42:43], v[42:43], v[46:47]
  buffer_store_dwordx4 v[40:43], v155, s[16:19], s30 offen sc0 sc1
  s_add_u32 s30, s30, 18432
PB3_51:
  s_cbranch_execz PB3_52
  s_branch L_exit
PB3_52:
  s_branch PB3_ret
L_a3:
  s_mov_b64 exec, 0
  s_branch PA3_0
PA3_ret:
  s_mov_b64 exec, -1
  s_mov_b32 s34, 4
  v_and_b32 v158, 3, v2
  v_lshlrev_b32 v158, 2, v158
  v_add_u32 v158, 159808, v158
  s_mov_b32 s33, 0
  s_mov_b32 s30, 1342177280
L_pg_50:
  ds_read_b32 v159, v158
  s_add_u32 s33, s33, 1
  s_waitcnt lgkmcnt(0)
  v_cmp_gt_u32 vcc, 159772, v159
  s_cmp_gt_u32 s33, 160000
  s_cbranch_scc1 L_pg_50x
  s_cbranch_vccz L_pg_50x
  s_sleep 32
  s_branch L_pg_50
L_pg_50x:
  v_and_b32 v158, 3, v2
  v_lshlrev_b32 v158, 2, v158
  v_add_u32 v158, 159808, v158
  s_mov_b32 s33, 0
  s_mov_b32 s30, 1342177280
L_pg_51:
  ds_read_b32 v159, v158
  s_add_u32 s33, s33, 1
  s_waitcnt lgkmcnt(0)
  v_cmp_gt_u32 vcc, 1073741824, v159
  s_cmp_gt_u32 s33, 160000
  s_cbranch_scc1 L_pg_51x
  s_cbranch_vccz L_pg_51x
  s_sleep 3
  s_branch L_pg_51
L_pg_51x:
  v_cmp_eq_u32 vcc, s30, v159
  s_cbranch_vccz L_af_49
  s_barrier
  s_barrier
  s_barrier
  s_mov_b32 s34, 8
L_af_49:
  s_setprio 3
  s_cmp_ge_u32 s21, 30
  s_cbranch_scc1 L_exit
  s_mov_b32 s33, 0
L_sp_52:
  ds_read_b32 v158, v156 offset:20
  s_add_u32 s33, s33, 1
  s_waitcnt lgkmcnt(0)
  v_readfirstlane_b32 s32, v158
  s_cmp_ge_u32 s32, s34
  s_cbranch_scc1 L_sp_52x
  s_cmp_lt_u32 s33, 320000
  s_cbranch_scc1 L_sp_52
L_sp_52x:
  s_lshl_b32 s34, s57, 7
  s_add_u32 s34, s34, 17835008
  v_lshlrev_b32 v12, 2, v1
  v_lshrrev_b32 v9, 5, v2
  v_bfe_u32 v10, v2, 2, 2
  v_lshl_add_u32 v11, v9, 3, v10
  v_lshlrev_b32 v11, 6, v11
  v_bfe_u32 v10, v2, 4, 1
  v_lshl_add_u32 v11, v10, 5, v11
  v_and_b32 v10, 3, v2
  v_lshl_add_u32 v4, v10, 3, v11
  v_add_u32 v5, 100352, v4
  v_mul_u32_u24 v6, 4608, v1
  v_lshl_add_u32 v6, v9, 4, v6
  v_lshl_add_u32 v7, v9, 9, v12
  ds_read_b64_tr_b16 v[16:17], v4 offset:0
  ds_read_b64_tr_b16 v[18:19], v4 offset:256
  ds_read_b64_tr_b16 v[20:21], v4 offset:1024
  ds_read_b64_tr_b16 v[22:23], v4 offset:1280
  ds_read_b64_tr_b16 v[24:25], v4 offset:2048
  ds_read_b64_tr_b16 v[26:27], v4 offset:2304
  ds_read_b64_tr_b16 v[28:29], v4 offset:3072
  ds_read_b64_tr_b16 v[30:31], v4 offset:3328
  ds_read_b64_tr_b16 v[32:33], v4 offset:4096
  ds_read_b64_tr_b16 v[34:35], v4 offset:4352
  ds_read_b64_tr_b16 v[36:37], v4 offset:5120
  ds_read_b64_tr_b16 v[38:39], v4 offset:5376
  s_lshl_b32 s30, s51, 2
  s_add_u32 s30, s30, 159888
  v_mov_b32 v14, s30
  s_mov_b32 s33, 0
L_pollF4:
  buffer_load_dword v13, v12, s[4:7], s34 offen sc0 sc1
  s_waitcnt vmcnt(0)
  v_cmp_ne_u32 vcc, 1, v13
  s_add_u32 s33, s33, 1
  s_cmp_gt_u32 s33, 20000
  s_cbranch_scc1 L_pollF4_x
  s_cbranch_vccz L_pollF4_x
  s_sleep 1
  s_branch L_pollF4
L_pollF4_x:
PA3_0:
  s_cbranch_execz PA3_1
  s_mul_i32 s30, s57, 37888
  s_add_u32 s30, s30, 8388608
  buffer_load_dwordx4 v[100:103], v3, s[4:7], s30 offen offset:0 sc0 sc1
  buffer_load_dwordx4 v[104:107], v3, s[4:7], s30 offen offset:1024 sc0 sc1
  buffer_load_dwordx4 v[108:111], v3, s[4:7], s30 offen offset:2048 sc0 sc1
  buffer_load_dwordx4 v[112:115], v3, s[4:7], s30 offen offset:3072 sc0 sc1
  s_add_u32 s30, s30, 4096
PA3_1:
  s_cbranch_execz PA3_2
  buffer_load_dwordx4 v[116:119], v3, s[4:7], s30 offen offset:0 sc0 sc1
  buffer_load_dwordx4 v[120:123], v3, s[4:7], s30 offen offset:1024 sc0 sc1
  buffer_load_dwordx4 v[124:127], v3, s[4:7], s30 offen offset:2048 sc0 sc1
  buffer_load_dwordx4 v[128:131], v3, s[4:7], s30 offen offset:3072 sc0 sc1
  s_add_u32 s30, s30, 4096
  buffer_load_dwordx4 v[132:135], v3, s[4:7], s30 offen offset:0 sc0 sc1
  buffer_load_dwordx4 v[136:139], v3, s[4:7], s30 offen offset:1024 sc0 sc1
PA3_2:
  s_cbranch_execz PA3_3
  buffer_load_dwordx4 v[140:143], v3, s[4:7], s30 offen offset:2048 sc0 sc1
  buffer_load_dwordx4 v[144:147], v3, s[4:7], s30 offen offset:3072 sc0 sc1
  s_add_u32 s30, s30, 4096
  buffer_load_dwordx4 v[148:151], v3, s[4:7], s30 offen offset:0 sc0 sc1
  buffer_load_dwordx4 v[152:155], v3, s[4:7], s30 offen offset:1024 sc0 sc1
  buffer_load_dwordx4 v[156:159], v3, s[4:7], s30 offen offset:2048 sc0 sc1
  buffer_load_dwordx4 v[160:163], v3, s[4:7], s30 offen offset:3072 sc0 sc1
PA3_3:
  s_cbranch_execz PA3_4
  s_add_u32 s30, s30, 4096
  s_waitcnt vmcnt(15) lgkmcnt(6)
  v_mfma_f32_32x32x16_bf16 v[52:67], v[16:19], v[100:103], 0
  ds_read_b64_tr_b16 v[40:41], v4 offset:6144
  ds_read_b64_tr_b16 v[42:43], v4 offset:6400
  ds_read_b64_tr_b16 v[44:45], v4 offset:7168
  v_mfma_f32_32x32x16_bf16 v[68:83], v[20:23], v[100:103], 0
PA3_4:
  s_cbranch_execz PA3_5
  ds_read_b64_tr_b16 v[46:47], v4 offset:7424
  ds_read_b64_tr_b16 v[48:49], v4 offset:8192
  ds_read_b64_tr_b16 v[50:51], v4 offset:8448
  v_mfma_f32_32x32x16_bf16 v[84:99], v[24:27], v[100:103], 0
  buffer_load_dwordx4 v[100:103], v3, s[4:7], s30 offen offset:0 sc0 sc1
  s_waitcnt vmcnt(15) lgkmcnt(6)
  v_mfma_f32_32x32x16_bf16 v[52:67], v[28:31], v[104:107], v[52:67]
PA3_5:
  s_cbranch_execz PA3_6
  ds_read_b64_tr_b16 v[16:17], v4 offset:9216
  ds_read_b64_tr_b16 v[18:19], v4 offset:9472
  ds_read_b64_tr_b16 v[20:21], v4 offset:10240
  v_mfma_f32_32x32x16_bf16 v[68:83], v[32:35], v[104:107], v[68:83]
  ds_read_b64_tr_b16 v[22:23], v4 offset:10496
  ds_read_b64_tr_b16 v[24:25], v4 offset:11264
  ds_read_b64_tr_b16 v[26:27], v4 offset:11520
PA3_6:
  s_cbranch_execz PA3_7
  v_mfma_f32_32x32x16_bf16 v[84:99], v[36:39], v[104:107], v[84:99]
  buffer_load_dwordx4 v[104:107], v3, s[4:7], s30 offen offset:1024 sc0 sc1
  s_waitcnt vmcnt(15) lgkmcnt(6)
  v_mfma_f32_32x32x16_bf16 v[52:67], v[40:43], v[108:111], v[52:67]
  ds_read_b64_tr_b16 v[28:29], v4 offset:12288
  ds_read_b64_tr_b16 v[30:31], v4 offset:12544
  ds_read_b64_tr_b16 v[32:33], v4 offset:13312
PA3_7:
  s_cbranch_execz PA3_8
  v_mfma_f32_32x32x16_bf16 v[68:83], v[44:47], v[108:111], v[68:83]
  ds_read_b64_tr_b16 v[34:35], v4 offset:13568
  ds_read_b64_tr_b16 v[36:37], v4 offset:14336
  ds_read_b64_tr_b16 v[38:39], v4 offset:14592
  v_mfma_f32_32x32x16_bf16 v[84:99], v[48:51], v[108:111], v[84:99]
  buffer_load_dwordx4 v[108:111], v3, s[4:7], s30 offen offset:2048 sc0 sc1
  s_waitcnt vmcnt(15) lgkmcnt(6)
PA3_8:
  s_cbranch_execz PA3_9
  v_mfma_f32_32x32x16_bf16 v[52:67], v[16:19], v[112:115], v[52:67]
  ds_read_b64_tr_b16 v[40:41], v4 offset:15360
  ds_read_b64_tr_b16 v[42:43], v4 offset:15616
  ds_read_b64_tr_b16 v[44:45], v4 offset:16384
  v_mfma_f32_32x32x16_bf16 v[68:83], v[20:23], v[112:115], v[68:83]
  ds_read_b64_tr_b16 v[46:47], v4 offset:16640
  ds_read_b64_tr_b16 v[48:49], v4 offset:17408
PA3_9:
  s_cbranch_execz PA3_10
  ds_read_b64_tr_b16 v[50:51], v4 offset:17664
  v_mfma_f32_32x32x16_bf16 v[84:99], v[24:27], v[112:115], v[84:99]
  buffer_load_dwordx4 v[112:115], v3, s[4:7], s30 offen offset:3072 sc0 sc1
  s_add_u32 s30, s30, 4096
  s_waitcnt vmcnt(15) lgkmcnt(6)
  v_mfma_f32_32x32x16_bf16 v[52:67], v[28:31], v[116:119], v[52:67]
  ds_read_b64_tr_b16 v[16:17], v4 offset:18432
PA3_10:
  s_cbranch_execz PA3_11
  ds_read_b64_tr_b16 v[18:19], v4 offset:18688
  ds_read_b64_tr_b16 v[20:21], v4 offset:19456
  v_mfma_f32_32x32x16_bf16 v[68:83], v[32:35], v[116:119], v[68:83]
  ds_read_b64_tr_b16 v[22:23], v4 offset:19712
  ds_read_b64_tr_b16 v[24:25], v4 offset:20480
  ds_read_b64_tr_b16 v[26:27], v4 offset:20736
  v_mfma_f32_32x32x16_bf16 v[84:99], v[36:39], v[116:119], v[84:99]
PA3_11:
  s_cbranch_execz PA3_12
  buffer_load_dwordx4 v[116:119], v3, s[4:7], s30 offen offset:0 sc0 sc1
  s_waitcnt vmcnt(15) lgkmcnt(6)
  v_mfma_f32_32x32x16_bf16 v[52:67], v[40:43], v[120:123], v[52:67]
  ds_read_b64_tr_b16 v[28:29], v4 offset:21504
  ds_read_b64_tr_b16 v[30:31], v4 offset:21760
  ds_read_b64_tr_b16 v[32:33], v4 offset:22528
  v_mfma_f32_32x32x16_bf16 v[68:83], v[44:47], v[120:123], v[68:83]
PA3_12:
  s_cbranch_execz PA3_13
  ds_read_b64_tr_b16 v[34:35], v4 offset:22784
  ds_read_b64_tr_b16 v[36:37], v4 offset:23552
  ds_read_b64_tr_b16 v[38:39], v4 offset:23808
  v_mfma_f32_32x32x16_bf16 v[84:99], v[48:51], v[120:123], v[84:99]
  buffer_load_dwordx4 v[120:123], v3, s[4:7], s30 offen offset:1024 sc0 sc1
  s_waitcnt vmcnt(15) lgkmcnt(6)
  v_mfma_f32_32x32x16_bf16 v[52:67], v[16:19], v[124:127], v[52:67]
PA3_13:
  s_cbranch_execz PA3_14
  ds_read_b64_tr_b16 v[40:41], v4 offset:24576
  ds_read_b64_tr_b16 v[42:43], v4 offset:24832
  ds_read_b64_tr_b16 v[44:45], v4 offset:25600
  v_mfma_f32_32x32x16_bf16 v[68:83], v[20:23], v[124:127], v[68:83]
  ds_read_b64_tr_b16 v[46:47], v4 offset:25856
  ds_read_b64_tr_b16 v[48:49], v4 offset:26624
  ds_read_b64_tr_b16 v[50:51], v4 offset:26880
PA3_14:
  s_cbranch_execz PA3_15
  v_mfma_f32_32x32x16_bf16 v[84:99], v[24:27], v[124:127], v[84:99]
  buffer_load_dwordx4 v[124:127], v3, s[4:7], s30 offen offset:2048 sc0 sc1
  s_waitcnt vmcnt(15) lgkmcnt(6)
  v_mfma_f32_32x32x16_bf16 v[52:67], v[28:31], v[128:131], v[52:67]
  ds_read_b64_tr_b16 v[16:17], v4 offset:27648
  ds_read_b64_tr_b16 v[18:19], v4 offset:27904
  ds_read_b64_tr_b16 v[20:21], v4 offset:28672
PA3_15:
  s_cbranch_execz PA3_16
  v_mfma_f32_32x32x16_bf16 v[68:83], v[32:35], v[128:131], v[68:83]
  ds_read_b64_tr_b16 v[22:23], v4 offset:28928
  ds_read_b64_tr_b16 v[24:25], v4 offset:29696
  ds_read_b64_tr_b16 v[26:27], v4 offset:29952
  v_mfma_f32_32x32x16_bf16 v[84:99], v[36:39], v[128:131], v[84:99]
  buffer_load_dwordx4 v[128:131], v3, s[4:7], s30 offen offset:3072 sc0 sc1
  s_add_u32 s30, s30, 4096
PA3_16:
  s_cbranch_execz PA3_17
  s_waitcnt vmcnt(15) lgkmcnt(6)
  v_mfma_f32_32x32x16_bf16 v[52:67], v[40:43], v[132:135], v[52:67]
  ds_read_b64_tr_b16 v[28:29], v4 offset:30720
  ds_read_b64_tr_b16 v[30:31], v4 offset:30976
  ds_read_b64_tr_b16 v[32:33], v4 offset:31744
  v_mfma_f32_32x32x16_bf16 v[68:83], v[44:47], v[132:135], v[68:83]
  ds_read_b64_tr_b16 v[34:35], v4 offset:32000
PA3_17:
  s_cbranch_execz PA3_18
  ds_read_b64_tr_b16 v[36:37], v4 offset:32768
  ds_read_b64_tr_b16 v[38:39], v4 offset:33024
  v_mfma_f32_32x32x16_bf16 v[84:99], v[48:51], v[132:135], v[84:99]
  buffer_load_dwordx4 v[132:135], v3, s[4:7], s30 offen offset:0 sc0 sc1
  s_waitcnt vmcnt(15) lgkmcnt(6)
  v_mfma_f32_32x32x16_bf16 v[52:67], v[16:19], v[136:139], v[52:67]
  ds_read_b64_tr_b16 v[40:41], v4 offset:33792
PA3_18:
  s_cbranch_execz PA3_19
  ds_read_b64_tr_b16 v[42:43], v4 offset:34048
  ds_read_b64_tr_b16 v[44:45], v4 offset:34816
  v_mfma_f32_32x32x16_bf16 v[68:83], v[20:23], v[136:139], v[68:83]
  ds_read_b64_tr_b16 v[46:47], v4 offset:35072
  ds_read_b64_tr_b16 v[48:49], v4 offset:35840
  ds_read_b64_tr_b16 v[50:51], v4 offset:36096
  v_mfma_f32_32x32x16_bf16 v[84:99], v[24:27], v[136:139], v[84:99]
PA3_19:
  s_cbranch_execz PA3_20
  buffer_load_dwordx4 v[136:139], v3, s[4:7], s30 offen offset:1024 sc0 sc1
  s_waitcnt vmcnt(15) lgkmcnt(6)
  v_mfma_f32_32x32x16_bf16 v[52:67], v[28:31], v[140:143], v[52:67]
  ds_read_b64_tr_b16 v[16:17], v4 offset:36864
  ds_read_b64_tr_b16 v[18:19], v4 offset:37120
  ds_read_b64_tr_b16 v[20:21], v4 offset:37888
  v_mfma_f32_32x32x16_bf16 v[68:83], v[32:35], v[140:143], v[68:83]
PA3_20:
  s_cbranch_execz PA3_21
  ds_read_b64_tr_b16 v[22:23], v4 offset:38144
  ds_read_b64_tr_b16 v[24:25], v4 offset:38912
  ds_read_b64_tr_b16 v[26:27], v4 offset:39168
  v_mfma_f32_32x32x16_bf16 v[84:99], v[36:39], v[140:143], v[84:99]
  buffer_load_dwordx4 v[140:143], v3, s[4:7], s30 offen offset:2048 sc0 sc1
  s_waitcnt vmcnt(15) lgkmcnt(6)
  v_mfma_f32_32x32x16_bf16 v[52:67], v[40:43], v[144:147], v[52:67]
PA3_21:
  s_cbranch_execz PA3_22
  ds_read_b64_tr_b16 v[28:29], v4 offset:39936
  ds_read_b64_tr_b16 v[30:31], v4 offset:40192
  ds_read_b64_tr_b16 v[32:33], v4 offset:40960
  v_mfma_f32_32x32x16_bf16 v[68:83], v[44:47], v[144:147], v[68:83]
  ds_read_b64_tr_b16 v[34:35], v4 offset:41216
  ds_read_b64_tr_b16 v[36:37], v4 offset:41984
  ds_read_b64_tr_b16 v[38:39], v4 offset:42240
PA3_22:
  s_cbranch_execz PA3_23
  v_mfma_f32_32x32x16_bf16 v[84:99], v[48:51], v[144:147], v[84:99]
  buffer_load_dwordx4 v[144:147], v3, s[4:7], s30 offen offset:3072 sc0 sc1
  s_add_u32 s30, s30, 4096
  s_waitcnt vmcnt(15) lgkmcnt(6)
  v_mfma_f32_32x32x16_bf16 v[52:67], v[16:19], v[148:151], v[52:67]
  ds_read_b64_tr_b16 v[40:41], v4 offset:43008
  ds_read_b64_tr_b16 v[42:43], v4 offset:43264
PA3_23:
  s_cbranch_execz PA3_24
  ds_read_b64_tr_b16 v[44:45], v4 offset:44032
  v_mfma_f32_32x32x16_bf16 v[68:83], v[20:23], v[148:151], v[68:83]
  ds_read_b64_tr_b16 v[46:47], v4 offset:44288
  ds_read_b64_tr_b16 v[48:49], v4 offset:45056
  ds_read_b64_tr_b16 v[50:51], v4 offset:45312
  v_mfma_f32_32x32x16_bf16 v[84:99], v[24:27], v[148:151], v[84:99]
  buffer_load_dwordx4 v[148:151], v3, s[4:7], s30 offen offset:0 sc0 sc1
PA3_24:
  s_cbranch_execz PA3_25
  s_waitcnt vmcnt(15) lgkmcnt(6)
  v_mfma_f32_32x32x16_bf16 v[52:67], v[28:31], v[152:155], v[52:67]
  ds_read_b64_tr_b16 v[16:17], v4 offset:46080
  ds_read_b64_tr_b16 v[18:19], v4 offset:46336
  ds_read_b64_tr_b16 v[20:21], v4 offset:47104
  v_mfma_f32_32x32x16_bf16 v[68:83], v[32:35], v[152:155], v[68:83]
  ds_read_b64_tr_b16 v[22:23], v4 offset:47360
PA3_25:
  s_cbranch_execz PA3_26
  ds_read_b64_tr_b16 v[24:25], v4 offset:48128
  ds_read_b64_tr_b16 v[26:27], v4 offset:48384
  v_mfma_f32_32x32x16_bf16 v[84:99], v[36:39], v[152:155], v[84:99]
  buffer_load_dwordx4 v[152:155], v3, s[4:7], s30 offen offset:1024 sc0 sc1
  s_waitcnt vmcnt(15) lgkmcnt(6)
  v_mfma_f32_32x32x16_bf16 v[52:67], v[40:43], v[156:159], v[52:67]
  ds_read_b64_tr_b16 v[28:29], v4 offset:49152
PA3_26:
  s_cbranch_execz PA3_27
  ds_read_b64_tr_b16 v[30:31], v4 offset:49408
  ds_read_b64_tr_b16 v[32:33], v4 offset:50176
  v_mfma_f32_32x32x16_bf16 v[68:83], v[44:47], v[156:159], v[68:83]
  ds_read_b64_tr_b16 v[34:35], v4 offset:50432
  ds_read_b64_tr_b16 v[36:37], v4 offset:51200
  ds_read_b64_tr_b16 v[38:39], v4 offset:51456
  v_mfma_f32_32x32x16_bf16 v[84:99], v[48:51], v[156:159], v[84:99]
PA3_27:
  s_cbranch_execz PA3_28
  buffer_load_dwordx4 v[156:159], v3, s[4:7], s30 offen offset:2048 sc0 sc1
  s_waitcnt vmcnt(15) lgkmcnt(6)
  v_mfma_f32_32x32x16_bf16 v[52:67], v[16:19], v[160:163], v[52:67]
  ds_read_b64_tr_b16 v[40:41], v4 offset:52224
  ds_read_b64_tr_b16 v[42:43], v4 offset:52480
  ds_read_b64_tr_b16 v[44:45], v4 offset:53248
  v_mfma_f32_32x32x16_bf16 v[68:83], v[20:23], v[160:163], v[68:83]
PA3_28:
  s_cbranch_execz PA3_29
  ds_read_b64_tr_b16 v[46:47], v4 offset:53504
  ds_read_b64_tr_b16 v[48:49], v4 offset:54272
  ds_read_b64_tr_b16 v[50:51], v4 offset:54528
  v_mfma_f32_32x32x16_bf16 v[84:99], v[24:27], v[160:163], v[84:99]
  buffer_load_dwordx4 v[160:163], v3, s[4:7], s30 offen offset:3072 sc0 sc1
  s_add_u32 s30, s30, 4096
  s_waitcnt vmcnt(15) lgkmcnt(6)
PA3_29:
  s_cbranch_execz PA3_30
  v_mfma_f32_32x32x16_bf16 v[52:67], v[28:31], v[100:103], v[52:67]
  ds_read_b64_tr_b16 v[16:17], v5 offset:0
  ds_read_b64_tr_b16 v[18:19], v5 offset:256
  ds_read_b64_tr_b16 v[20:21], v5 offset:1024
  v_mfma_f32_32x32x16_bf16 v[68:83], v[32:35], v[100:103], v[68:83]
  ds_read_b64_tr_b16 v[22:23], v5 offset:1280
  ds_read_b64_tr_b16 v[24:25], v5 offset:2048
PA3_30:
  s_cbranch_execz PA3_31
  ds_read_b64_tr_b16 v[26:27], v5 offset:2304
  v_mfma_f32_32x32x16_bf16 v[84:99], v[36:39], v[100:103], v[84:99]
  buffer_load_dword v100, v7, s[4:7], s30 offen offset:0 sc0 sc1
  buffer_load_dword v101, v7, s[4:7], s30 offen offset:128 sc0 sc1
  buffer_load_dword v102, v7, s[4:7], s30 offen offset:256 sc0 sc1
  buffer_load_dword v103, v7, s[4:7], s30 offen offset:384 sc0 sc1
  s_waitcnt vmcnt(18) lgkmcnt(6)
PA3_31:
  s_cbranch_execz PA3_32
  v_mfma_f32_32x32x16_bf16 v[52:67], v[40:43], v[104:107], v[52:67]
  ds_read_b64_tr_b16 v[28:29], v5 offset:3072
  ds_read_b64_tr_b16 v[30:31], v5 offset:3328
  ds_read_b64_tr_b16 v[32:33], v5 offset:4096
  v_mfma_f32_32x32x16_bf16 v[68:83], v[44:47], v[104:107], v[68:83]
  ds_read_b64_tr_b16 v[34:35], v5 offset:4352
  ds_read_b64_tr_b16 v[36:37], v5 offset:5120
PA3_32:
  s_cbranch_execz PA3_33
  ds_read_b64_tr_b16 v[38:39], v5 offset:5376
  v_mfma_f32_32x32x16_bf16 v[84:99], v[48:51], v[104:107], v[84:99]
  buffer_load_dword v104, v7, s[4:7], s30 offen offset:1024 sc0 sc1
  buffer_load_dword v105, v7, s[4:7], s30 offen offset:1152 sc0 sc1
  buffer_load_dword v106, v7, s[4:7], s30 offen offset:1280 sc0 sc1
  buffer_load_dword v107, v7, s[4:7], s30 offen offset:1408 sc0 sc1
  s_waitcnt vmcnt(21) lgkmcnt(6)
PA3_33:
  s_cbranch_execz PA3_34
  v_mfma_f32_32x32x16_bf16 v[52:67], v[16:19], v[108:111], v[52:67]
  ds_read_b64_tr_b16 v[40:41], v5 offset:6144
  ds_read_b64_tr_b16 v[42:43], v5 offset:6400
  ds_read_b64_tr_b16 v[44:45], v5 offset:7168
  v_mfma_f32_32x32x16_bf16 v[68:83], v[20:23], v[108:111], v[68:83]
  ds_read_b64_tr_b16 v[46:47], v5 offset:7424
  ds_read_b64_tr_b16 v[48:49], v5 offset:8192
PA3_34:
  s_cbranch_execz PA3_35
  ds_read_b64_tr_b16 v[50:51], v5 offset:8448
  v_mfma_f32_32x32x16_bf16 v[84:99], v[24:27], v[108:111], v[84:99]
  buffer_load_dword v108, v7, s[4:7], s30 offen offset:2048 sc0 sc1
  buffer_load_dword v109, v7, s[4:7], s30 offen offset:2176 sc0 sc1
  buffer_load_dword v110, v7, s[4:7], s30 offen offset:2304 sc0 sc1
  buffer_load_dword v111, v7, s[4:7], s30 offen offset:2432 sc0 sc1
  s_waitcnt vmcnt(24) lgkmcnt(6)
PA3_35:
  s_cbranch_execz PA3_36
  v_mfma_f32_32x32x16_bf16 v[52:67], v[28:31], v[112:115], v[52:67]
  ds_read_b64_tr_b16 v[16:17], v5 offset:9216
  ds_read_b64_tr_b16 v[18:19], v5 offset:9472
  ds_read_b64_tr_b16 v[20:21], v5 offset:10240
  v_mfma_f32_32x32x16_bf16 v[68:83], v[32:35], v[112:115], v[68:83]
  ds_read_b64_tr_b16 v[22:23], v5 offset:10496
  ds_read_b64_tr_b16 v[24:25], v5 offset:11264
PA3_36:
  s_cbranch_execz PA3_37
  ds_read_b64_tr_b16 v[26:27], v5 offset:11520
  v_mfma_f32_32x32x16_bf16 v[84:99], v[36:39], v[112:115], v[84:99]
  buffer_load_dword v112, v7, s[4:7], s30 offen offset:3072 sc0 sc1
  buffer_load_dword v113, v7, s[4:7], s30 offen offset:3200 sc0 sc1
  buffer_load_dword v114, v7, s[4:7], s30 offen offset:3328 sc0 sc1
  buffer_load_dword v115, v7, s[4:7], s30 offen offset:3456 sc0 sc1
  s_waitcnt vmcnt(27) lgkmcnt(6)
PA3_37:
  s_cbranch_execz PA3_38
  v_mfma_f32_32x32x16_bf16 v[52:67], v[40:43], v[116:119], v[52:67]
  ds_read_b64_tr_b16 v[28:29], v5 offset:12288
  ds_read_b64_tr_b16 v[30:31], v5 offset:12544
  ds_read_b64_tr_b16 v[32:33], v5 offset:13312
  v_mfma_f32_32x32x16_bf16 v[68:83], v[44:47], v[116:119], v[68:83]
  ds_read_b64_tr_b16 v[34:35], v5 offset:13568
  ds_read_b64_tr_b16 v[36:37], v5 offset:14336
PA3_38:
  s_cbranch_execz PA3_39
  ds_read_b64_tr_b16 v[38:39], v5 offset:14592
  v_mfma_f32_32x32x16_bf16 v[84:99], v[48:51], v[116:119], v[84:99]
  s_waitcnt vmcnt(26) lgkmcnt(6)
  v_mfma_f32_32x32x16_bf16 v[52:67], v[16:19], v[120:123], v[52:67]
  ds_read_b64_tr_b16 v[40:41], v5 offset:15360
  ds_read_b64_tr_b16 v[42:43], v5 offset:15616
  ds_read_b64_tr_b16 v[44:45], v5 offset:16384
PA3_39:
  s_cbranch_execz PA3_40
  v_mfma_f32_32x32x16_bf16 v[68:83], v[20:23], v[120:123], v[68:83]
  ds_read_b64_tr_b16 v[46:47], v5 offset:16640
  ds_read_b64_tr_b16 v[48:49], v5 offset:17408
  ds_read_b64_tr_b16 v[50:51], v5 offset:17664
  v_mfma_f32_32x32x16_bf16 v[84:99], v[24:27], v[120:123], v[84:99]
  s_waitcnt vmcnt(25) lgkmcnt(6)
  v_mfma_f32_32x32x16_bf16 v[52:67], v[28:31], v[124:127], v[52:67]
PA3_40:
  s_cbranch_execz PA3_41
  ds_read_b64_tr_b16 v[16:17], v5 offset:18432
  ds_read_b64_tr_b16 v[18:19], v5 offset:18688
  ds_read_b64_tr_b16 v[20:21], v5 offset:19456
  v_mfma_f32_32x32x16_bf16 v[68:83], v[32:35], v[124:127], v[68:83]
  ds_read_b64_tr_b16 v[22:23], v5 offset:19712
  ds_read_b64_tr_b16 v[24:25], v5 offset:20480
  ds_read_b64_tr_b16 v[26:27], v5 offset:20736
PA3_41:
  s_cbranch_execz PA3_42
  v_mfma_f32_32x32x16_bf16 v[84:99], v[36:39], v[124:127], v[84:99]
  s_waitcnt vmcnt(24) lgkmcnt(6)
  v_mfma_f32_32x32x16_bf16 v[52:67], v[40:43], v[128:131], v[52:67]
  ds_read_b64_tr_b16 v[28:29], v5 offset:21504
  ds_read_b64_tr_b16 v[30:31], v5 offset:21760
  ds_read_b64_tr_b16 v[32:33], v5 offset:22528
  v_mfma_f32_32x32x16_bf16 v[68:83], v[44:47], v[128:131], v[68:83]
PA3_42:
  s_cbranch_execz PA3_43
  ds_read_b64_tr_b16 v[34:35], v5 offset:22784
  ds_read_b64_tr_b16 v[36:37], v5 offset:23552
  ds_read_b64_tr_b16 v[38:39], v5 offset:23808
  v_mfma_f32_32x32x16_bf16 v[84:99], v[48:51], v[128:131], v[84:99]
  s_waitcnt vmcnt(23) lgkmcnt(6)
  v_mfma_f32_32x32x16_bf16 v[52:67], v[16:19], v[132:135], v[52:67]
  ds_read_b64_tr_b16 v[40:41], v5 offset:24576
PA3_43:
  s_cbranch_execz PA3_44
  ds_read_b64_tr_b16 v[42:43], v5 offset:24832
  ds_read_b64_tr_b16 v[44:45], v5 offset:25600
  v_mfma_f32_32x32x16_bf16 v[68:83], v[20:23], v[132:135], v[68:83]
  ds_read_b64_tr_b16 v[46:47], v5 offset:25856
  ds_read_b64_tr_b16 v[48:49], v5 offset:26624
  ds_read_b64_tr_b16 v[50:51], v5 offset:26880
  v_mfma_f32_32x32x16_bf16 v[84:99], v[24:27], v[132:135], v[84:99]
PA3_44:
  s_cbranch_execz PA3_45
  s_waitcnt vmcnt(22) lgkmcnt(6)
  v_mfma_f32_32x32x16_bf16 v[52:67], v[28:31], v[136:139], v[52:67]
  ds_read_b64_tr_b16 v[16:17], v5 offset:27648
  ds_read_b64_tr_b16 v[18:19], v5 offset:27904
  ds_read_b64_tr_b16 v[20:21], v5 offset:28672
  v_mfma_f32_32x32x16_bf16 v[68:83], v[32:35], v[136:139], v[68:83]
  ds_read_b64_tr_b16 v[22:23], v5 offset:28928
PA3_45:
  s_cbranch_execz PA3_46
  ds_read_b64_tr_b16 v[24:25], v5 offset:29696
  ds_read_b64_tr_b16 v[26:27], v5 offset:29952
  v_mfma_f32_32x32x16_bf16 v[84:99], v[36:39], v[136:139], v[84:99]
  s_waitcnt vmcnt(21) lgkmcnt(6)
  v_mfma_f32_32x32x16_bf16 v[52:67], v[40:43], v[140:143], v[52:67]
  ds_read_b64_tr_b16 v[28:29], v5 offset:30720
  ds_read_b64_tr_b16 v[30:31], v5 offset:30976
PA3_46:
  s_cbranch_execz PA3_47
  ds_read_b64_tr_b16 v[32:33], v5 offset:31744
  v_mfma_f32_32x32x16_bf16 v[68:83], v[44:47], v[140:143], v[68:83]
  ds_read_b64_tr_b16 v[34:35], v5 offset:32000
  ds_read_b64_tr_b16 v[36:37], v5 offset:32768
  ds_read_b64_tr_b16 v[38:39], v5 offset:33024
  v_mfma_f32_32x32x16_bf16 v[84:99], v[48:51], v[140:143], v[84:99]
  s_waitcnt vmcnt(20) lgkmcnt(6)
PA3_47:
  s_cbranch_execz PA3_48
  v_mfma_f32_32x32x16_bf16 v[52:67], v[16:19], v[144:147], v[52:67]
  ds_read_b64_tr_b16 v[40:41], v5 offset:33792
  ds_read_b64_tr_b16 v[42:43], v5 offset:34048
  ds_read_b64_tr_b16 v[44:45], v5 offset:34816
  v_mfma_f32_32x32x16_bf16 v[68:83], v[20:23], v[144:147], v[68:83]
  ds_read_b64_tr_b16 v[46:47], v5 offset:35072
  ds_read_b64_tr_b16 v[48:49], v5 offset:35840
PA3_48:
  s_cbranch_execz PA3_49
  ds_read_b64_tr_b16 v[50:51], v5 offset:36096
  v_mfma_f32_32x32x16_bf16 v[84:99], v[24:27], v[144:147], v[84:99]
  s_waitcnt vmcnt(19) lgkmcnt(6)
  v_mfma_f32_32x32x16_bf16 v[52:67], v[28:31], v[148:151], v[52:67]
  ds_read_b64_tr_b16 v[16:17], v5 offset:36864
  ds_read_b64_tr_b16 v[18:19], v5 offset:37120
  ds_read_b64_tr_b16 v[20:21], v5 offset:37888
PA3_49:
  s_cbranch_execz PA3_50
  v_mfma_f32_32x32x16_bf16 v[68:83], v[32:35], v[148:151], v[68:83]
  ds_read_b64_tr_b16 v[22:23], v5 offset:38144
  ds_read_b64_tr_b16 v[24:25], v5 offset:38912
  ds_read_b64_tr_b16 v[26:27], v5 offset:39168
  v_mfma_f32_32x32x16_bf16 v[84:99], v[36:39], v[148:151], v[84:99]
  s_waitcnt vmcnt(18) lgkmcnt(6)
  v_mfma_f32_32x32x16_bf16 v[52:67], v[40:43], v[152:155], v[52:67]
PA3_50:
  s_cbranch_execz PA3_51
  ds_read_b64_tr_b16 v[28:29], v5 offset:39936
  ds_read_b64_tr_b16 v[30:31], v5 offset:40192
  ds_read_b64_tr_b16 v[32:33], v5 offset:40960
  v_mfma_f32_32x32x16_bf16 v[68:83], v[44:47], v[152:155], v[68:83]
  ds_read_b64_tr_b16 v[34:35], v5 offset:41216
  ds_read_b64_tr_b16 v[36:37], v5 offset:41984
  ds_read_b64_tr_b16 v[38:39], v5 offset:42240
PA3_51:
  s_cbranch_execz PA3_52
  v_mfma_f32_32x32x16_bf16 v[84:99], v[48:51], v[152:155], v[84:99]
  s_waitcnt vmcnt(17) lgkmcnt(6)
  v_mfma_f32_32x32x16_bf16 v[52:67], v[16:19], v[156:159], v[52:67]
  ds_read_b64_tr_b16 v[40:41], v5 offset:43008
  ds_read_b64_tr_b16 v[42:43], v5 offset:43264
  ds_read_b64_tr_b16 v[44:45], v5 offset:44032
  v_mfma_f32_32x32x16_bf16 v[68:83], v[20:23], v[156:159], v[68:83]
PA3_52:
  s_cbranch_execz PA3_53
  ds_read_b64_tr_b16 v[46:47], v5 offset:44288
  ds_read_b64_tr_b16 v[48:49], v5 offset:45056
  ds_read_b64_tr_b16 v[50:51], v5 offset:45312
  v_mfma_f32_32x32x16_bf16 v[84:99], v[24:27], v[156:159], v[84:99]
  s_waitcnt vmcnt(16) lgkmcnt(6)
  v_mfma_f32_32x32x16_bf16 v[52:67], v[28:31], v[160:163], v[52:67]
  ds_read_b64_tr_b16 v[16:17], v5 offset:46080
PA3_53:
  s_cbranch_execz PA3_54
  ds_read_b64_tr_b16 v[18:19], v5 offset:46336
  ds_read_b64_tr_b16 v[20:21], v5 offset:47104
  v_mfma_f32_32x32x16_bf16 v[68:83], v[32:35], v[160:163], v[68:83]
  ds_read_b64_tr_b16 v[22:23], v5 offset:47360
  ds_read_b64_tr_b16 v[24:25], v5 offset:48128
  ds_read_b64_tr_b16 v[26:27], v5 offset:48384
  v_mfma_f32_32x32x16_bf16 v[84:99], v[36:39], v[160:163], v[84:99]
PA3_54:
  s_cbranch_execz PA3_55
  s_waitcnt vmcnt(12) lgkmcnt(6)
  v_mfma_f32_32x32x16_bf16 v[52:67], v[40:43], v[100:103], v[52:67]
  ds_read_b64_tr_b16 v[28:29], v5 offset:49152
  ds_read_b64_tr_b16 v[30:31], v5 offset:49408
  ds_read_b64_tr_b16 v[32:33], v5 offset:50176
  v_mfma_f32_32x32x16_bf16 v[68:83], v[44:47], v[100:103], v[68:83]
  ds_read_b64_tr_b16 v[34:35], v5 offset:50432
PA3_55:
  s_cbranch_execz PA3_56
  ds_read_b64_tr_b16 v[36:37], v5 offset:51200
  ds_read_b64_tr_b16 v[38:39], v5 offset:51456
  v_mfma_f32_32x32x16_bf16 v[84:99], v[48:51], v[100:103], v[84:99]
  s_waitcnt vmcnt(8) lgkmcnt(6)
  v_mfma_f32_32x32x16_bf16 v[52:67], v[16:19], v[104:107], v[52:67]
  ds_read_b64_tr_b16 v[40:41], v5 offset:52224
  ds_read_b64_tr_b16 v[42:43], v5 offset:52480
PA3_56:
  s_cbranch_execz PA3_57
  ds_read_b64_tr_b16 v[44:45], v5 offset:53248
  v_mfma_f32_32x32x16_bf16 v[68:83], v[20:23], v[104:107], v[68:83]
  ds_read_b64_tr_b16 v[46:47], v5 offset:53504
  ds_read_b64_tr_b16 v[48:49], v5 offset:54272
  ds_read_b64_tr_b16 v[50:51], v5 offset:54528
  v_mfma_f32_32x32x16_bf16 v[84:99], v[24:27], v[104:107], v[84:99]
  s_mul_i32 s31, s51, 11264
PA3_57:
  s_cbranch_execz PA3_58
  s_add_u32 s31, s31, 55296
  v_mul_u32_u24 v8, 272, v1
  v_lshl_add_u32 v8, v9, 4, v8
  v_add_u32 v8, s31, v8
  v_lshrrev_b32 v10, 4, v2
  v_and_b32 v11, 15, v2
  v_mul_u32_u24 v12, 272, v10
PA3_58:
  s_cbranch_execz PA3_59
  v_lshl_add_u32 v12, v11, 4, v12
  v_add_u32 v12, s31, v12
  v_mul_u32_u24 v13, 4608, v10
  v_lshl_add_u32 v13, v11, 4, v13
  s_waitcnt vmcnt(4) lgkmcnt(6)
  v_mfma_f32_32x32x16_bf16 v[52:67], v[28:31], v[108:111], v[52:67]
  v_mfma_f32_32x32x16_bf16 v[68:83], v[32:35], v[108:111], v[68:83]
PA3_59:
  s_cbranch_execz PA3_60
  v_mfma_f32_32x32x16_bf16 v[84:99], v[36:39], v[108:111], v[84:99]
  v_lshrrev_b32 v10, 3, v2
  v_and_b32 v11, 7, v2
  v_mul_u32_u24 v14, 272, v10
  v_lshl_add_u32 v14, v11, 4, v14
  v_add_u32 v14, s31, v14
  v_mul_u32_u24 v15, 4608, v10
PA3_60:
  s_cbranch_execz PA3_61
  v_lshl_add_u32 v15, v11, 4, v15
  s_mul_i32 s30, s57, 147456
  s_sub_u32 s31, s38, 9
  s_mul_i32 s31, s31, 384
  s_add_u32 s30, s30, s31
  s_add_u32 s31, s30, 256
  s_waitcnt vmcnt(0) lgkmcnt(0)
PA3_61:
  s_cbranch_execz PA3_62
  v_mfma_f32_32x32x16_bf16 v[52:67], v[40:43], v[112:115], v[52:67]
  v_mfma_f32_32x32x16_bf16 v[68:83], v[44:47], v[112:115], v[68:83]
  v_mfma_f32_32x32x16_bf16 v[84:99], v[48:51], v[112:115], v[84:99]
  s_nop 9
  ds_write_b128 v8, v[52:55] offset:0
  ds_write_b128 v8, v[56:59] offset:32
  ds_write_b128 v8, v[60:63] offset:64
PA3_62:
  s_cbranch_execz PA3_63
  ds_write_b128 v8, v[64:67] offset:96
  ds_write_b128 v8, v[68:71] offset:128
  ds_write_b128 v8, v[72:75] offset:160
  ds_write_b128 v8, v[76:79] offset:192
  ds_write_b128 v8, v[80:83] offset:224
  s_waitcnt lgkmcnt(4)
  ds_read_b128 v[100:103], v12 offset:0
PA3_63:
  s_cbranch_execz PA3_64
  ds_read_b128 v[104:107], v12 offset:1088
  ds_read_b128 v[108:111], v12 offset:2176
  ds_read_b128 v[112:115], v12 offset:3264
  ds_read_b128 v[116:119], v12 offset:4352
  ds_read_b128 v[120:123], v12 offset:5440
  ds_read_b128 v[124:127], v12 offset:6528
  ds_read_b128 v[128:131], v12 offset:7616
PA3_64:
  s_cbranch_execz PA3_65
  s_waitcnt lgkmcnt(6)
  ds_write_b128 v8, v[84:87] offset:0
  ds_write_b128 v8, v[88:91] offset:32
  ds_write_b128 v8, v[92:95] offset:64
  ds_write_b128 v8, v[96:99] offset:96
  ds_read_b128 v[132:135], v14 offset:0
  ds_read_b128 v[136:139], v14 offset:2176
PA3_65:
  s_cbranch_execz PA3_66
  ds_read_b128 v[140:143], v14 offset:4352
  ds_read_b128 v[144:147], v14 offset:6528
  s_waitcnt lgkmcnt(14)
  buffer_store_dwordx4 v[100:103], v13, s[16:19], s30 offen sc0 sc1
  s_add_u32 s30, s30, 18432
  s_waitcnt lgkmcnt(14)
  buffer_store_dwordx4 v[104:107], v13, s[16:19], s30 offen sc0 sc1
PA3_66:
  s_cbranch_execz PA3_67
  s_add_u32 s30, s30, 18432
  s_waitcnt lgkmcnt(13)
  buffer_store_dwordx4 v[108:111], v13, s[16:19], s30 offen sc0 sc1
  s_add_u32 s30, s30, 18432
  s_waitcnt lgkmcnt(12)
  buffer_store_dwordx4 v[112:115], v13, s[16:19], s30 offen sc0 sc1
  s_add_u32 s30, s30, 18432
PA3_67:
  s_cbranch_execz PA3_68
  s_waitcnt lgkmcnt(11)
  buffer_store_dwordx4 v[116:119], v13, s[16:19], s30 offen sc0 sc1
  s_add_u32 s30, s30, 18432
  s_waitcnt lgkmcnt(10)
  buffer_store_dwordx4 v[120:123], v13, s[16:19], s30 offen sc0 sc1
  s_add_u32 s30, s30, 18432
  s_waitcnt lgkmcnt(9)
PA3_68:
  s_cbranch_execz PA3_69
  buffer_store_dwordx4 v[124:127], v13, s[16:19], s30 offen sc0 sc1
  s_add_u32 s30, s30, 18432
  s_waitcnt lgkmcnt(8)
  buffer_store_dwordx4 v[128:131], v13, s[16:19], s30 offen sc0 sc1
  s_add_u32 s30, s30, 18432
  s_waitcnt lgkmcnt(3)
  buffer_store_dwordx4 v[132:135], v15, s[16:19], s31 offen sc0 sc1
PA3_69:
  s_cbranch_execz PA3_70
  s_add_u32 s31, s31, 36864
  s_waitcnt lgkmcnt(2)
  buffer_store_dwordx4 v[136:139], v15, s[16:19], s31 offen sc0 sc1
  s_add_u32 s31, s31, 36864
  s_waitcnt lgkmcnt(1)
  buffer_store_dwordx4 v[140:143], v15, s[16:19], s31 offen sc0 sc1
  s_add_u32 s31, s31, 36864
PA3_70:
  s_cbranch_execz PA3_71
  s_waitcnt lgkmcnt(0)
  buffer_store_dwordx4 v[144:147], v15, s[16:19], s31 offen sc0 sc1
  s_add_u32 s31, s31, 36864
  s_branch L_exit
PA3_71:
  s_branch PA3_ret
L_exit:
  s_endpgm
L_g1_0s:
  s_mov_b32 s33, 0
L_sp_53:
  ds_read_b32 v158, v155 offset:4
  s_add_u32 s33, s33, 1
  s_waitcnt lgkmcnt(0)
  v_readfirstlane_b32 s32, v158
  s_cmp_ge_u32 s32, 4
  s_cbranch_scc1 L_sp_53x
  s_cmp_lt_u32 s33, 320000
  s_cbranch_scc1 L_sp_53
L_sp_53x:
  s_branch L_g1_0r
L_g1_1s:
  s_mov_b32 s33, 0
L_sp_54:
  ds_read_b32 v158, v155 offset:8
  s_add_u32 s33, s33, 1
  s_waitcnt lgkmcnt(0)
  v_readfirstlane_b32 s32, v158
  s_cmp_ge_u32 s32, 4
  s_cbranch_scc1 L_sp_54x
  s_cmp_lt_u32 s33, 320000
  s_cbranch_scc1 L_sp_54
L_sp_54x:
  s_branch L_g1_1r
L_g1_2s:
  s_mov_b32 s33, 0
L_sp_55:
  ds_read_b32 v158, v155 offset:12
  s_add_u32 s33, s33, 1
  s_waitcnt lgkmcnt(0)
  v_readfirstlane_b32 s32, v158
  s_cmp_ge_u32 s32, 4
  s_cbranch_scc1 L_sp_55x
  s_cmp_lt_u32 s33, 320000
  s_cbranch_scc1 L_sp_55
L_sp_55x:
  s_branch L_g1_2r
L_g1_3s:
  s_mov_b32 s33, 0
L_sp_56:
  ds_read_b32 v158, v155 offset:16
  s_add_u32 s33, s33, 1
  s_waitcnt lgkmcnt(0)
  v_readfirstlane_b32 s32, v158
  s_cmp_ge_u32 s32, 4
  s_cbranch_scc1 L_sp_56x
  s_cmp_lt_u32 s33, 320000
  s_cbranch_scc1 L_sp_56
L_sp_56x:
  s_branch L_g1_3r
L_g1_4s:
  s_mov_b32 s33, 0
L_sp_57:
  ds_read_b32 v158, v155 offset:20
  s_add_u32 s33, s33, 1
  s_waitcnt lgkmcnt(0)
  v_readfirstlane_b32 s32, v158
  s_cmp_ge_u32 s32, 4
  s_cbranch_scc1 L_sp_57x
  s_cmp_lt_u32 s33, 320000
  s_cbranch_scc1 L_sp_57
L_sp_57x:
  s_branch L_g1_4r
L_g1_5s:
  s_mov_b32 s33, 0
L_sp_58:
  ds_read_b32 v158, v155 offset:24
  s_add_u32 s33, s33, 1
  s_waitcnt lgkmcnt(0)
  v_readfirstlane_b32 s32, v158
  s_cmp_ge_u32 s32, 4
  s_cbranch_scc1 L_sp_58x
  s_cmp_lt_u32 s33, 320000
  s_cbranch_scc1 L_sp_58
L_sp_58x:
  s_branch L_g1_5r
L_g1_6s:
  s_mov_b32 s33, 0
L_sp_59:
  ds_read_b32 v158, v155 offset:28
  s_add_u32 s33, s33, 1
  s_waitcnt lgkmcnt(0)
  v_readfirstlane_b32 s32, v158
  s_cmp_ge_u32 s32, 4
  s_cbranch_scc1 L_sp_59x
  s_cmp_lt_u32 s33, 320000
  s_cbranch_scc1 L_sp_59
L_sp_59x:
  s_branch L_g1_6r
L_g1_7s:
  s_mov_b32 s33, 0
L_sp_60:
  ds_read_b32 v158, v155 offset:32
  s_add_u32 s33, s33, 1
  s_waitcnt lgkmcnt(0)
  v_readfirstlane_b32 s32, v158
  s_cmp_ge_u32 s32, 4
  s_cbranch_scc1 L_sp_60x
  s_cmp_lt_u32 s33, 320000
  s_cbranch_scc1 L_sp_60
L_sp_60x:
  s_branch L_g1_7r
L_end:
  s_endpgm
.section .rodata,"a"
.p2align 6
.amdhsa_kernel concat_heads__softmax_full_mha__ssm_conv_s5__prompt_kernel
  .amdhsa_next_free_vgpr 168
  .amdhsa_next_free_sgpr 100
  .amdhsa_accum_offset 168
  .amdhsa_group_segment_fixed_size 0
  .amdhsa_kernarg_size 120
  .amdhsa_user_sgpr_count 2
  .amdhsa_user_sgpr_kernarg_segment_ptr 1
  .amdhsa_system_sgpr_workgroup_id_x 1
.end_amdhsa_kernel
```
